```python
import torch

def _softmax(x, axis=-1):
    return torch.softmax(x, dim=axis)

def _gelu(x):
    return torch.nn.functional.gelu(x, approximate='tanh')

def _silu(x):
    return torch.nn.functional.silu(x)

def _sigmoid(x):
    return torch.sigmoid(x)

def _layernorm(x, axis=-1, eps=1e-05):
    m = x.mean(dim=axis, keepdim=True)
    v = x.var(dim=axis, keepdim=True, unbiased=False)
    return (x - m) / torch.sqrt(v + eps)

def _scatter_add(tgt, idx, src, axis=0):
    return tgt.clone().index_add_(axis, idx, src)

def _segment_sum(src, seg, n):
    out = torch.zeros((n,) + src.shape[1:], dtype=src.dtype)
    return out.index_add_(0, seg, src)

def _pad(x, pw):
    flat = tuple((v for pair in reversed(pw) for v in pair))
    return torch.nn.functional.pad(x, flat)
kernel_name = 'adaLN_cond__sliding_block_cached__swiglu_ffn__decode'

def setup_inputs():

    _w = lambda a: (lambda t: t.to(torch.bfloat16) if t.is_floating_point() else t)(torch.as_tensor(a))

    def _A_setup():
        B, Sq, D = (8, 1, 512)
        Hq, Hkv, Sk, Dh = (32, 8, 8192, 128)
        assert Hq % Hkv == 0, (Hq, Hkv)
        return {'x': _w((lambda *s: torch.randn(*s, dtype=torch.bfloat16) * 0.05)(B, Sq, D)), 'k_cache': _w((lambda *s: torch.randn(*s, dtype=torch.bfloat16) * 3.2)(B, Hkv, Sk, Dh)), 'v_cache': _w((lambda *s: torch.randn(*s, dtype=torch.bfloat16) * 0.4)(B, Hkv, Sk, Dh)), 'wq': _w((lambda *s: torch.randn(*s, dtype=torch.bfloat16) * 3.2)(D, Hq * Dh) * D ** (-0.5)), 'wo': _w((lambda *s: torch.randn(*s, dtype=torch.bfloat16) * 0.4)(Hq * Dh, D) * (Hq * Dh) ** (-0.5))}
    _A_in = _A_setup()

    def _B_setup():
        B, S, D, F = (8, 1, 512, 1792)
        return {'x': _w((lambda *s: torch.randn(*s, dtype=torch.bfloat16) * 0.05)(B, S, D)), 'w_gate': _w((lambda *s: torch.randn(*s, dtype=torch.bfloat16) * 0.05)(D, F)), 'w_up': _w((lambda *s: torch.randn(*s, dtype=torch.bfloat16) * 0.05)(D, F)), 'w_down': _w((lambda *s: torch.randn(*s, dtype=torch.bfloat16) * 0.05)(F, D))}
    _B_in = _B_setup()
    return {'A_x': _A_in['x'], 'A_k_cache': _A_in['k_cache'], 'A_v_cache': _A_in['v_cache'], 'A_wq': _A_in['wq'], 'A_wo': _A_in['wo'], 'B_x': _B_in['x'], 'B_w_gate': _B_in['w_gate'], 'B_w_up': _B_in['w_up'], 'B_w_down': _B_in['w_down'], 'c': _w((lambda *s: torch.randn(*s, dtype=torch.bfloat16) * 0.1)(8, 512) * 8.0), 'w_mod': _w((lambda *s: torch.randn(*s, dtype=torch.bfloat16) * 0.1)(512, 6 * 512) * 512 ** (-0.5) * 8.0)}

def reference(A_x, A_k_cache, A_v_cache, A_wq, A_wo, B_x, B_w_gate, B_w_up, B_w_down, c, w_mod):

    def _A_ref(x, k_cache, v_cache, wq, wo):
        B, Sq, D = x.shape
        Hq, Dh = (32, 128)
        Hkv, Sk = (k_cache.shape[1], k_cache.shape[2])
        W = min(4096, max(256, Sk // 4))
        rep = Hq // Hkv
        q = (lambda x, *d: x.permute(*d))((x @ wq).reshape(B, Sq, Hq, Dh), 0, 2, 1, 3)
        k = (lambda x, n, axis: torch.repeat_interleave(x, n, dim=axis))(k_cache[:, :, Sk - W:, :], rep, axis=1)
        v = (lambda x, n, axis: torch.repeat_interleave(x, n, dim=axis))(v_cache[:, :, Sk - W:, :], rep, axis=1)
        scores = torch.einsum('bhqd,bhkd->bhqk', q, k) * Dh ** (-0.5)
        p = _softmax(scores, axis=-1)
        o = torch.einsum('bhqk,bhkd->bhqd', p, v)
        return (lambda x, *d: x.permute(*d))(o, 0, 2, 1, 3).reshape(B, Sq, Hq * Dh) @ wo

    def _B_ref(x, w_gate, w_up, w_down):
        g = _silu(x @ w_gate)
        u = x @ w_up
        return g * u @ w_down
    x = A_x
    mod = (_silu(c) @ w_mod).reshape(c.shape[0], 6, 1, -1)
    sa, ca, ga, sb, cb, gb = (mod[:, 0].clone(), mod[:, 1].clone(), mod[:, 2].clone(), mod[:, 3].clone(), mod[:, 4].clone(), mod[:, 5].clone())
    h = _layernorm(x, axis=-1) * (1 + ca) + sa
    x = x + ga * _A_ref(h, A_k_cache, A_v_cache, A_wq, A_wo)
    h = _layernorm(x, axis=-1) * (1 + cb) + sb
    x = x + gb * _B_ref(h, B_w_gate, B_w_up, B_w_down)
    return x
```

```asm
; @launch grid=(256,1,1) block=(1024,1,1) lds=144384
.amdgcn_target "amdgcn-amd-amdhsa--gfx950"
.text
.globl adaLN_cond__sliding_block_cached__swiglu_ffn__decode_kernel
.p2align 8
.type adaLN_cond__sliding_block_cached__swiglu_ffn__decode_kernel,@function
adaLN_cond__sliding_block_cached__swiglu_ffn__decode_kernel:
    s_cmp_ge_u32 s2, 256
    s_cbranch_scc1 L_END
    s_load_dwordx16 s[32:47], s[0:1], 0
    s_load_dwordx8 s[48:55], s[0:1], 64
    s_load_dwordx4 s[56:59], s[0:1], 96
    v_and_b32 v1, 63, v0
    v_lshrrev_b32 v2, 6, v0
    s_nop 0
    v_readfirstlane_b32 s3, v2
    s_and_b32 s4, s2, 7
    s_bfe_u32 s5, s2, 0x30003
    s_lshr_b32 s6, s2, 6
    s_mov_b32 s7, 0
    s_mov_b32 s72, 0x200000
    s_lshl_b32 s73, s4, 3
    s_add_u32 s73, s73, s5
    s_and_b32 s74, s3, 7
    v_mov_b32 v3, 141312
    v_lshl_add_u32 v4, v1, 2, v3
    v_mov_b32 v5, 0
    s_cmp_lg_u32 s3, 0
    s_cbranch_scc1 L_NOINIT
    ds_write_b32 v4, v5
L_NOINIT:
    s_lshl_b32 s76, s5, 24
    s_lshl_b32 s77, s4, 21
    s_add_u32 s76, s76, s77
    s_add_u32 s76, s76, 0x180000
    s_mov_b32 s10, 0x80000
    s_mov_b32 s11, 0x20000
    s_mov_b32 s14, 0x1c0000
    s_mov_b32 s15, 0x20000
    s_mov_b32 s18, 6291456
    s_mov_b32 s19, 0x20000
    s_mov_b32 s26, 0x300000
    s_mov_b32 s27, 0x20000
    s_mov_b32 s30, 0x2000
    s_mov_b32 s31, 0x20000
    s_mov_b32 s62, 0x2000
    s_mov_b32 s63, 0x20000
    s_mov_b32 s66, 0x2000
    s_mov_b32 s67, 0x20000
    s_mov_b32 s70, 0x100
    s_mov_b32 s71, 0x20000
    s_mov_b32 s22, 0x400000
    s_mov_b32 s23, 0x20000
    s_mov_b32 s94, 1310720
    s_mov_b32 s95, 0x20000
    s_cmp_eq_u32 s6, 3
    s_cselect_b32 s22, 0x1c0000, s22
    v_lshlrev_b32 v4, 4, v1
    s_and_b32 s86, s6, 1
    s_lshl_b32 s80, s86, 18
    s_lshr_b32 s81, s3, 3
    s_lshl_b32 s81, s81, 5
    s_and_b32 s82, s3, 7
    s_add_u32 s81, s81, s82
    s_lshl_b32 s81, s81, 12
    s_add_u32 s80, s80, s81
    s_or_b32 s81, s2, s3
    s_memrealtime s[96:97]
    s_waitcnt lgkmcnt(0)
    s_mov_b64 s[68:69], s[56:57]
    s_cmp_lg_u32 s81, 0
    s_cbranch_scc1 L_NOE
    s_or_b32 s81, s96, 1
    v_mov_b32 v5, s81
    v_lshlrev_b32 v6, 7, v1
    s_mov_b64 exec, 3
    buffer_store_dword v5, v6, s[68:71], 0 offen sc1
    s_mov_b64 exec, -1
L_NOE:
    s_cmp_ge_u32 s6, 2
    s_cselect_b64 s[8:9], s[34:35], s[36:37]
    s_add_u32 s8, s8, s76
    s_addc_u32 s9, s9, 0
    s_cmp_lt_u32 s6, 2
    s_cbranch_scc1 L_NKP
    s_cmp_ge_u32 s3, 8
    s_cbranch_scc1 L_NKP
    buffer_load_dwordx4 v[16:19], v4, s[8:11], s80 offen offset:0 nt
    buffer_load_dwordx4 v[20:23], v4, s[8:11], s80 offen offset:1024 nt
    buffer_load_dwordx4 v[24:27], v4, s[8:11], s80 offen offset:2048 nt
    buffer_load_dwordx4 v[28:31], v4, s[8:11], s80 offen offset:3072 nt
L_NKP:
    s_mov_b64 s[24:25], s[52:53]
    s_mov_b64 s[28:29], s[50:51]
    s_mov_b64 s[60:61], s[32:33]
    s_mov_b64 s[92:93], s[58:59]
    s_mov_b64 s[16:17], s[58:59]
    s_mov_b64 s[12:13], s[48:49]
    s_mov_b64 s[64:65], s[54:55]
    s_mov_b64 s[20:21], s[38:39]
    s_cmp_eq_u32 s6, 2
    s_cselect_b64 s[20:21], s[40:41], s[20:21]
    s_cmp_lt_u32 s5, 4
    s_cselect_b64 s[76:77], s[44:45], s[46:47]
    s_cmp_eq_u32 s6, 3
    s_cselect_b64 s[20:21], s[76:77], s[20:21]
    s_add_u32 s100, s58, 1572864
    s_addc_u32 s101, s59, 0
    s_cmp_lg_u32 s3, 14
    s_cbranch_scc1 L_NE14
    s_and_b32 s80, s2, 1
    s_lshl_b32 s80, s80, 7
    v_mov_b32 v9, s80
    buffer_load_dword v12, v9, s[68:71], 0 offen sc1
    s_branch L_B0
L_NE14:
    s_cmp_ge_u32 s6, 2
    s_cbranch_scc1 L_PREK
    s_cmp_eq_u32 s3, 13
    s_cbranch_scc1 L_PRE13
    s_cmp_eq_u32 s3, 15
    s_cbranch_scc1 L_PREV15
    s_cmp_lg_u32 s6, 0
    s_cbranch_scc1 L_B0
    s_cmp_ge_u32 s3, 12
    s_cbranch_scc1 L_B0
    s_cmp_ge_u32 s3, 8
    s_cbranch_scc1 L_PREC
    s_and_b32 s80, s2, 15
    s_lshr_b32 s81, s2, 4
    v_lshrrev_b32 v14, 3, v1
    s_mov_b32 s77, 6144
    v_mul_lo_u32 v12, v14, s77
    v_bfe_u32 v14, v1, 4, 1
    v_lshlrev_b32 v14, 1, v14
    v_and_b32 v13, 7, v1
    v_xor_b32 v14, v14, v13
    v_lshlrev_b32 v14, 4, v14
    v_add_u32 v12, v12, v14
    v_xor_b32 v13, 64, v12
    s_lshl_b32 s84, s81, 7
    s_lshl_b32 s85, s3, 4
    s_add_u32 s84, s84, s85
    s_mul_i32 s84, s84, 6144
    s_lshl_b32 s85, s80, 7
    s_add_u32 s84, s84, s85
    s_lshl_b32 s85, s3, 11
    s_add_u32 s85, s85, 65536
    s_add_u32 s78, s84, 0
    s_add_u32 m0, s85, 0
    s_nop 0
    buffer_load_dwordx4 v12, s[24:27], s78 offen nt lds
    s_add_u32 s78, s84, 49152
    s_add_u32 m0, s85, 1024
    s_nop 0
    buffer_load_dwordx4 v13, s[24:27], s78 offen nt lds
    s_cmp_lt_u32 s3, 4
    s_cbranch_scc1 L_B0
    v_lshlrev_b32 v4, 4, v1
    s_and_b32 s87, s3, 3
    s_lshl_b32 s87, s87, 11
    buffer_load_dwordx4 v[88:91], v4, s[60:63], s87 offen
    buffer_load_dwordx4 v[92:95], v4, s[60:63], s87 offen offset:1024
    s_branch L_B0
L_PREC:
    v_lshlrev_b32 v4, 4, v1
    s_lshl_b32 s83, s74, 11
    buffer_load_dwordx4 v[104:107], v4, s[28:31], s83 offen
    buffer_load_dwordx4 v[100:103], v4, s[28:31], s83 offen offset:1024
    s_branch L_B0
L_PREV15:
    v_mov_b32 v8, -1
    v_mov_b32 v9, -1
    v_mov_b32 v10, -1
    v_mov_b32 v11, -1
    v_lshlrev_b32 v5, 4, v1
    s_lshl_b32 s80, s73, 10
    s_lshl_b32 s81, s6, 9
    s_add_u32 s81, s81, s80
    s_add_u32 s81, s81, 1048576
    s_mov_b32 exec_hi, 0
    buffer_store_dwordx4 v[8:11], v5, s[92:95], s81 offen
    s_mov_b64 exec, -1
    s_cmp_lg_u32 s6, 0
    s_cbranch_scc1 L_B0
    s_add_u32 s80, s80, 1179648
    buffer_store_dwordx4 v[8:11], v5, s[92:95], s80 offen
    s_branch L_B0
L_PREK:
    s_cmp_lt_u32 s3, 8
    s_cbranch_scc1 L_B0
    s_cmp_eq_u32 s3, 14
    s_cbranch_scc1 L_B0
    s_cmp_eq_u32 s3, 13
    s_cbranch_scc1 L_PRE13
    v_mov_b32 v8, -1
    v_mov_b32 v9, -1
    v_mov_b32 v10, -1
    v_mov_b32 v11, -1
    v_lshlrev_b32 v5, 4, v1
    s_and_b32 s81, s6, 1
    s_and_b32 s83, s2, 63
    s_lshl_b32 s83, s83, 11
    s_cmp_ge_u32 s3, 12
    s_cbranch_scc1 L_PREK2
    s_lshl_b32 s80, s73, 14
    s_lshl_b32 s82, s81, 13
    s_add_u32 s80, s80, s82
    s_lshl_b32 s82, s74, 11
    s_add_u32 s80, s80, s82
    buffer_store_dwordx4 v[8:11], v5, s[92:95], s80 offen
    buffer_store_dwordx4 v[8:11], v5, s[92:95], s80 offen offset:1024
    s_branch L_B0
L_PREK2:
    s_cmp_eq_u32 s3, 15
    s_cbranch_scc1 L_PREK3
    s_lshl_b32 s80, s73, 10
    s_lshl_b32 s82, s81, 9
    s_add_u32 s82, s82, s80
    s_add_u32 s82, s82, 1114112
    s_mov_b32 exec_hi, 0
    buffer_store_dwordx4 v[8:11], v5, s[92:95], s82 offen
    s_mov_b64 exec, -1
    s_cmp_eq_u32 s6, 2
    s_cbranch_scc1 L_PREK4
    s_add_u32 s80, s80, 1245184
    buffer_store_dwordx4 v[8:11], v5, s[92:95], s80 offen
    s_branch L_B0
L_PREK4:
    s_add_u32 s80, s83, 4456448
    s_branch L_PREK5
L_PREK3:
    s_cmp_lg_u32 s6, 2
    s_cbranch_scc1 L_B0
    s_add_u32 s80, s83, 4587520
L_PREK5:
    buffer_store_dwordx4 v[8:11], v5, s[16:19], s80 offen sc1
    buffer_store_dwordx4 v[8:11], v5, s[16:19], s80 offen offset:1024 sc1
    s_branch L_B0
L_PRE13:
    s_getpc_b64 s[80:81]
L_PC:
    s_sub_u32 s80, s80, L_PC-adaLN_cond__sliding_block_cached__swiglu_ffn__decode_kernel
    s_subb_u32 s81, s81, 0
    s_lshr_b32 s82, s2, 3
    s_lshl_b32 s82, s82, 10
    v_lshlrev_b32 v4, 4, v1
    v_add_u32 v4, s82, v4
    v_min_u32 v4, L_CODE_END-adaLN_cond__sliding_block_cached__swiglu_ffn__decode_kernel-16, v4
    global_load_dwordx4 v[100:103], v4, s[80:81]
L_B0:
    s_barrier
    s_cmp_eq_u32 s3, 14
    s_cbranch_scc1 L_EP
    s_cmp_eq_u32 s3, 15
    s_cbranch_scc1 L_SYNC
    s_cmp_eq_u32 s6, 0
    s_cbranch_scc1 L_TC
    s_cmp_eq_u32 s6, 1
    s_cbranch_scc1 L_TD
    s_cmp_lt_u32 s3, 8
    s_cbranch_scc1 L_KPATH
    s_cmp_eq_u32 s3, 13
    s_cbranch_scc1 L_KPATH
    s_waitcnt vmcnt(0)
    v_mov_b32 v5, 1
    s_mov_b64 exec, 1
    ds_add_u32 v3, v5 offset:32
    s_mov_b64 exec, -1
    s_branch L_KPATH
L_SYNC:
    s_setprio 3
    s_waitcnt vmcnt(0)
SPIN_1:
    ds_read_b32 v12, v3 offset:12
    s_waitcnt lgkmcnt(0)
    v_readfirstlane_b32 s76, v12
    s_nop 0
    s_cmp_ge_u32 s76, 1
    s_cbranch_scc1 SPD_2
    s_cmp_eq_u32 s72, 0
    s_cbranch_scc1 SPD_2
    s_sub_u32 s72, s72, 1
    s_sleep 1
    s_branch SPIN_1
SPD_2:
    s_cmp_lt_u32 s6, 2
    s_cbranch_scc1 L_SY1
SPIN_3:
    ds_read_b32 v7, v3 offset:32
    s_waitcnt lgkmcnt(0)
    v_readfirstlane_b32 s76, v7
    s_nop 0
    s_cmp_ge_u32 s76, 5
    s_cbranch_scc1 SPD_4
    s_cmp_eq_u32 s72, 0
    s_cbranch_scc1 SPD_4
    s_sub_u32 s72, s72, 1
    s_sleep 1
    s_branch SPIN_3
SPD_4:
L_SY1:
    s_getreg_b32 s83, hwreg(HW_REG_XCC_ID)
    v_mov_b32 v13, s83
    s_lshl_b32 s84, s2, 7
    s_add_u32 s84, s84, 4980736
    v_mov_b32 v14, s84
    s_mov_b64 exec, 1
    buffer_store_dwordx2 v[12:13], v14, s[16:19], 0 offen sc1
    s_mov_b64 exec, -1
    s_setprio 0
    s_cmp_ge_u32 s6, 2
    s_cbranch_scc1 L_KPATH
    s_branch L_VWAIT
L_EP:
    s_setprio 3
    s_and_b32 s80, s2, 1
    s_lshl_b32 s80, s80, 7
    v_mov_b32 v9, s80
L_EPL:
    s_waitcnt vmcnt(0)
    v_cmp_eq_u32 vcc, 0, v12
    s_cbranch_vccz L_EPD
    s_cmp_eq_u32 s72, 0
    s_cbranch_scc1 L_EPD
    s_sub_u32 s72, s72, 1
    buffer_load_dword v12, v9, s[68:71], 0 offen sc1
    s_branch L_EPL
L_EPD:
    ds_write_b32 v3, v12 offset:12
    s_setprio 0
    s_cmp_ge_u32 s6, 2
    s_cbranch_scc1 L_KPATH
    s_setprio 3
    s_mov_b32 s79, 0
    s_cmp_eq_u32 s6, 1
    s_cbranch_scc1 L_FG1
SPIN_5:
    ds_read_b32 v7, v3 offset:40
    s_waitcnt lgkmcnt(0)
    v_readfirstlane_b32 s76, v7
    s_nop 0
    s_cmp_ge_u32 s76, 1
    s_cbranch_scc1 SPD_6
    s_cmp_eq_u32 s72, 0
    s_cbranch_scc1 SPD_6
    s_sub_u32 s72, s72, 1
    s_sleep 2
    s_branch SPIN_5
SPD_6:
    s_branch L_FLAGS
L_FG1:
SPIN_7:
    ds_read_b32 v7, v3 offset:16
    s_waitcnt lgkmcnt(0)
    v_readfirstlane_b32 s76, v7
    s_nop 0
    s_cmp_ge_u32 s76, 8
    s_cbranch_scc1 SPD_8
    s_cmp_eq_u32 s72, 0
    s_cbranch_scc1 SPD_8
    s_sub_u32 s72, s72, 1
    s_sleep 2
    s_branch SPIN_7
SPD_8:
L_FLAGS:
    v_and_b32 v7, 31, v1
    v_lshlrev_b32 v14, 3, v7
    v_add_u32 v14, s4, v14
    v_lshrrev_b32 v15, 3, v7
    v_lshlrev_b32 v15, 6, v15
    v_and_b32 v7, 7, v1
    v_add_u32 v15, v15, v7
    s_lshl_b32 s84, s5, 3
    v_add_u32 v15, s84, v15
    s_mov_b32 vcc_lo, 0
    s_mov_b32 vcc_hi, -1
    v_cndmask_b32 v15, v14, v15, vcc
    v_lshlrev_b32 v15, 7, v15
    v_add_u32 v15, 4980736, v15
L_FLP:
    buffer_load_dwordx2 v[96:97], v15, s[16:19], 0 offen sc1
    s_waitcnt vmcnt(0)
    v_cmp_ne_u32 vcc, v96, v12
    s_cbranch_vccz L_FLD
    s_cmp_eq_u32 s72, 0
    s_cbranch_scc1 L_FLD
    s_sub_u32 s72, s72, 1
    s_sleep 8
    s_branch L_FLP
L_FLD:
    s_getreg_b32 s83, hwreg(HW_REG_XCC_ID)
    v_cmp_ne_u32 vcc, s83, v97
    s_nop 0
    s_cmp_eq_u32 vcc_lo, 0
    s_cselect_b32 s84, 1, 0
    v_mov_b32 v14, s84
    s_cmp_eq_u32 s84, 1
    s_cbranch_scc1 L_FLOK
    s_mov_b64 s[92:93], s[100:101]
    v_mov_b32 v8, -1
    v_mov_b32 v9, -1
    v_mov_b32 v10, -1
    v_mov_b32 v11, -1
    v_lshlrev_b32 v5, 4, v1
    s_cmp_ge_u32 s6, 2
    s_cbranch_scc1 L_CAK
    s_lshl_b32 s80, s73, 10
    s_lshl_b32 s81, s6, 9
    s_add_u32 s81, s81, s80
    s_add_u32 s81, s81, 1048576
    s_mov_b32 exec_hi, 0
    buffer_store_dwordx4 v[8:11], v5, s[92:95], s81 offen sc1
    s_mov_b64 exec, -1
    s_cmp_lg_u32 s6, 0
    s_cbranch_scc1 L_CAD
    s_add_u32 s80, s80, 1179648
    buffer_store_dwordx4 v[8:11], v5, s[92:95], s80 offen sc1
    s_branch L_CAD
L_CAK:
    s_lshl_b32 s80, s73, 14
    s_and_b32 s81, s6, 1
    s_lshl_b32 s82, s81, 13
    s_add_u32 s80, s80, s82
    buffer_store_dwordx4 v[8:11], v5, s[92:95], s80 offen offset:0 sc1
    buffer_store_dwordx4 v[8:11], v5, s[92:95], s80 offen offset:1024 sc1
    buffer_store_dwordx4 v[8:11], v5, s[92:95], s80 offen offset:2048 sc1
    buffer_store_dwordx4 v[8:11], v5, s[92:95], s80 offen offset:3072 sc1
    s_add_u32 s80, s80, 4096
    buffer_store_dwordx4 v[8:11], v5, s[92:95], s80 offen offset:0 sc1
    buffer_store_dwordx4 v[8:11], v5, s[92:95], s80 offen offset:1024 sc1
    buffer_store_dwordx4 v[8:11], v5, s[92:95], s80 offen offset:2048 sc1
    buffer_store_dwordx4 v[8:11], v5, s[92:95], s80 offen offset:3072 sc1
    s_lshl_b32 s80, s73, 10
    s_lshl_b32 s82, s81, 9
    s_add_u32 s82, s82, s80
    s_add_u32 s82, s82, 1114112
    s_mov_b32 exec_hi, 0
    buffer_store_dwordx4 v[8:11], v5, s[92:95], s82 offen sc1
    s_mov_b64 exec, -1
    s_cmp_lg_u32 s6, 3
    s_cbranch_scc1 L_CAD
    s_add_u32 s80, s80, 1245184
    buffer_store_dwordx4 v[8:11], v5, s[92:95], s80 offen sc1
L_CAD:
    s_lshl_b32 s80, s2, 7
    s_add_u32 s80, s80, 5013504
    v_mov_b32 v5, s80
    s_mov_b32 s80, 32768
    s_waitcnt vmcnt(0)
    s_mov_b64 exec, 1
    buffer_store_dword v12, v5, s[16:19], 0 offen sc1
    s_mov_b64 exec, -1
L_FBP:
    buffer_load_dword v8, v15, s[16:19], s80 offen sc1
    s_waitcnt vmcnt(0)
    v_cmp_ne_u32 vcc, v8, v12
    s_nop 0
    s_cmp_eq_u32 vcc_lo, 0
    s_cbranch_scc1 L_FLOK
    s_cmp_eq_u32 s72, 0
    s_cbranch_scc1 L_FLOK
    s_sub_u32 s72, s72, 1
    s_sleep 4
    s_branch L_FBP
L_FLOK:
    ds_write_b32 v3, v14 offset:8
    s_waitcnt lgkmcnt(0)
    v_mov_b32 v7, 1
    ds_write_b32 v3, v7 offset:36
    s_cmp_eq_u32 s79, 1
    s_cbranch_scc1 L_KFLB
    s_setprio 0
    s_branch L_VWAIT
L_TC:
    s_cmp_ge_u32 s3, 12
    s_cbranch_scc1 L_C_MT
    s_cmp_ge_u32 s3, 8
    s_cbranch_scc1 L_C_S
    s_cmp_ge_u32 s3, 4
    s_cbranch_scc1 L_C_LN
    v_lshrrev_b32 v6, 4, v1
    v_lshlrev_b32 v5, 10, v6
    v_and_b32 v6, 1, v6
    v_lshlrev_b32 v6, 1, v6
    v_bfe_u32 v7, v1, 3, 1
    v_or_b32 v6, v6, v7
    v_xor_b32 v6, s3, v6
    v_lshl_add_u32 v5, v6, 5, v5
    v_bfe_u32 v6, v1, 2, 2
    v_lshl_add_u32 v5, v6, 7, v5
    v_and_b32 v6, 3, v1
    v_lshl_add_u32 v5, v6, 3, v5
    v_add_u32 v5, 65536, v5
    s_lshl_b32 s84, s81, 8
    s_add_u32 s84, s84, 131072
    v_and_b32 v7, 7, v1
    v_mul_u32_u24 v6, 1056, v7
    v_lshrrev_b32 v7, 4, v1
    v_lshl_add_u32 v6, v7, 4, v6
    v_add_u32 v6, s84, v6
    s_lshl_b32 s86, s2, 11
    s_lshl_b32 s84, s3, 9
    s_add_u32 s86, s86, s84
    s_add_u32 s86, s86, 4718592
    v_and_b32 v7, 7, v1
    v_lshlrev_b32 v4, 6, v7
    v_lshrrev_b32 v7, 4, v1
    v_lshl_add_u32 v4, v7, 4, v4
    s_waitcnt vmcnt(0)
    v_mov_b32 v7, 1
    s_mov_b64 exec, 1
    ds_add_u32 v3, v7 offset:24
    s_mov_b64 exec, -1
SPIN_9:
    ds_read_b32 v12, v3 offset:12
    s_waitcnt lgkmcnt(0)
    v_readfirstlane_b32 s76, v12
    s_nop 0
    s_cmp_ge_u32 s76, 1
    s_cbranch_scc1 SPD_10
    s_cmp_eq_u32 s72, 0
    s_cbranch_scc1 SPD_10
    s_sub_u32 s72, s72, 1
    s_sleep 1
    s_branch SPIN_9
SPD_10:
    s_mov_b32 vcc_lo, 0xff00ff00
    s_mov_b32 vcc_hi, 0xff00ff00
    v_mov_b32 v7, 131072
    v_cndmask_b32 v7, 0, v7, vcc
    v_add_u32 v4, v4, v7
    v_cndmask_b32 v12, 0, v12, vcc
SPIN_11:
    ds_read_b32 v7, v3 offset:24
    s_waitcnt lgkmcnt(0)
    v_readfirstlane_b32 s76, v7
    s_nop 0
    s_cmp_ge_u32 s76, 12
    s_cbranch_scc1 SPD_12
    s_cmp_eq_u32 s72, 0
    s_cbranch_scc1 SPD_12
    s_sub_u32 s72, s72, 1
    s_branch SPIN_11
SPD_12:
    ds_read_b64_tr_b16 v[48:49], v5 offset:0
    ds_read_b64_tr_b16 v[50:51], v5 offset:512
    ds_read_b64_tr_b16 v[52:53], v5 offset:4096
    ds_read_b64_tr_b16 v[54:55], v5 offset:4608
    ds_read_b64_tr_b16 v[56:57], v5 offset:8192
    ds_read_b64_tr_b16 v[58:59], v5 offset:8704
    ds_read_b64_tr_b16 v[60:61], v5 offset:12288
    ds_read_b64_tr_b16 v[62:63], v5 offset:12800
    ds_read_b128 v[64:67], v6 offset:0
    ds_read_b128 v[68:71], v6 offset:64
    ds_read_b128 v[72:75], v6 offset:128
    ds_read_b128 v[76:79], v6 offset:192
    s_waitcnt lgkmcnt(3)
    v_mfma_f32_16x16x32_bf16 v[80:83], v[48:51], v[64:67], 0
    s_waitcnt lgkmcnt(2)
    v_mfma_f32_16x16x32_bf16 v[80:83], v[52:55], v[68:71], v[80:83]
    s_waitcnt lgkmcnt(1)
    v_mfma_f32_16x16x32_bf16 v[80:83], v[56:59], v[72:75], v[80:83]
    s_waitcnt lgkmcnt(0)
    v_mfma_f32_16x16x32_bf16 v[80:83], v[60:63], v[76:79], v[80:83]
    s_nop 7
    v_xor_b32 v80, v80, v12
    v_xor_b32 v81, v81, v12
    v_xor_b32 v82, v82, v12
    v_xor_b32 v83, v83, v12
    buffer_store_dwordx4 v[80:83], v4, s[16:19], s86 offen sc1
    v_mov_b32 v7, 1
    s_mov_b64 exec, 1
    ds_add_u32 v3, v7 offset:24
    s_mov_b64 exec, -1
    s_branch L_VWAIT
L_C_LN:
    s_waitcnt vmcnt(2)
    v_mov_b32 v5, 1
    s_mov_b64 exec, 1
    ds_add_u32 v3, v5 offset:24
    s_mov_b64 exec, -1
    s_waitcnt vmcnt(0)
    s_add_u32 s87, s87, 81920
    v_add_u32 v4, s87, v4
    v_lshlrev_b32 v48, 16, v88
    v_and_b32 v49, 0xffff0000, v88
    v_lshlrev_b32 v50, 16, v89
    v_and_b32 v51, 0xffff0000, v89
    v_lshlrev_b32 v52, 16, v90
    v_and_b32 v53, 0xffff0000, v90
    v_lshlrev_b32 v54, 16, v91
    v_and_b32 v55, 0xffff0000, v91
    v_readfirstlane_b32 s77, v48
    s_nop 1
    v_subrev_f32 v56, s77, v48
    v_subrev_f32 v57, s77, v49
    v_subrev_f32 v58, s77, v50
    v_subrev_f32 v59, s77, v51
    v_subrev_f32 v60, s77, v52
    v_subrev_f32 v61, s77, v53
    v_subrev_f32 v62, s77, v54
    v_subrev_f32 v63, s77, v55
    v_add_f32 v64, v56, v57
    v_mul_f32 v65, v56, v56
    v_fmac_f32 v65, v57, v57
    v_add_f32 v64, v64, v58
    v_fmac_f32 v65, v58, v58
    v_add_f32 v64, v64, v59
    v_fmac_f32 v65, v59, v59
    v_add_f32 v64, v64, v60
    v_fmac_f32 v65, v60, v60
    v_add_f32 v64, v64, v61
    v_fmac_f32 v65, v61, v61
    v_add_f32 v64, v64, v62
    v_fmac_f32 v65, v62, v62
    v_add_f32 v64, v64, v63
    v_fmac_f32 v65, v63, v63
    s_nop 0
    v_add_f32_dpp v64, v64, v64 quad_perm:[1,0,3,2] row_mask:0xf bank_mask:0xf
    v_add_f32_dpp v65, v65, v65 quad_perm:[1,0,3,2] row_mask:0xf bank_mask:0xf
    s_nop 0
    v_add_f32_dpp v64, v64, v64 quad_perm:[2,3,0,1] row_mask:0xf bank_mask:0xf
    v_add_f32_dpp v65, v65, v65 quad_perm:[2,3,0,1] row_mask:0xf bank_mask:0xf
    s_nop 0
    v_add_f32_dpp v64, v64, v64 row_half_mirror row_mask:0xf bank_mask:0xf
    v_add_f32_dpp v65, v65, v65 row_half_mirror row_mask:0xf bank_mask:0xf
    s_nop 0
    v_add_f32_dpp v64, v64, v64 row_mirror row_mask:0xf bank_mask:0xf
    v_add_f32_dpp v65, v65, v65 row_mirror row_mask:0xf bank_mask:0xf
    v_mov_b32 v66, v64
    v_mov_b32 v67, v65
    s_nop 0
    v_permlane16_swap_b32 v64, v66
    v_permlane16_swap_b32 v65, v67
    v_add_f32 v64, v64, v66
    v_add_f32 v65, v65, v67
    v_mov_b32 v66, v64
    v_mov_b32 v67, v65
    s_nop 0
    v_permlane32_swap_b32 v64, v66
    v_permlane32_swap_b32 v65, v67
    v_add_f32 v64, v64, v66
    v_add_f32 v65, v65, v67
    v_mul_f32 v64, 0x3b000000, v64
    v_mul_f32 v65, 0x3b000000, v65
    v_fma_f32 v65, -v64, v64, v65
    v_max_f32 v65, 0, v65
    v_add_f32 v64, s77, v64
    v_cvt_pk_bf16_f32 v66, v64, v65
    v_lshlrev_b32 v64, 16, v66
    v_and_b32 v65, 0xffff0000, v66
    v_add_f32 v65, 0x3727c5ac, v65
    v_cvt_pk_bf16_f32 v66, v65, v65
    v_lshlrev_b32 v65, 16, v66
    v_sqrt_f32 v65, v65
    s_nop 0
    v_cvt_pk_bf16_f32 v66, v65, v65
    v_lshlrev_b32 v65, 16, v66
    v_rcp_f32 v65, v65
    v_sub_f32 v48, v48, v64
    v_sub_f32 v49, v49, v64
    v_sub_f32 v50, v50, v64
    v_sub_f32 v51, v51, v64
    v_sub_f32 v52, v52, v64
    v_sub_f32 v53, v53, v64
    v_sub_f32 v54, v54, v64
    v_sub_f32 v55, v55, v64
    v_cvt_pk_bf16_f32 v56, v48, v49
    v_lshlrev_b32 v48, 16, v56
    v_and_b32 v49, 0xffff0000, v56
    v_cvt_pk_bf16_f32 v57, v50, v51
    v_lshlrev_b32 v50, 16, v57
    v_and_b32 v51, 0xffff0000, v57
    v_cvt_pk_bf16_f32 v58, v52, v53
    v_lshlrev_b32 v52, 16, v58
    v_and_b32 v53, 0xffff0000, v58
    v_cvt_pk_bf16_f32 v59, v54, v55
    v_lshlrev_b32 v54, 16, v59
    v_and_b32 v55, 0xffff0000, v59
    v_mul_f32 v48, v48, v65
    v_mul_f32 v49, v49, v65
    v_mul_f32 v50, v50, v65
    v_mul_f32 v51, v51, v65
    v_mul_f32 v52, v52, v65
    v_mul_f32 v53, v53, v65
    v_mul_f32 v54, v54, v65
    v_mul_f32 v55, v55, v65
    v_cvt_pk_bf16_f32 v56, v48, v49
    v_lshlrev_b32 v48, 16, v56
    v_and_b32 v49, 0xffff0000, v56
    v_cvt_pk_bf16_f32 v57, v50, v51
    v_lshlrev_b32 v50, 16, v57
    v_and_b32 v51, 0xffff0000, v57
    v_cvt_pk_bf16_f32 v58, v52, v53
    v_lshlrev_b32 v52, 16, v58
    v_and_b32 v53, 0xffff0000, v58
    v_cvt_pk_bf16_f32 v59, v54, v55
    v_lshlrev_b32 v54, 16, v59
    v_and_b32 v55, 0xffff0000, v59
    v_cvt_pk_bf16_f32 v88, v48, v49
    v_cvt_pk_bf16_f32 v89, v50, v51
    v_cvt_pk_bf16_f32 v90, v52, v53
    v_cvt_pk_bf16_f32 v91, v54, v55
    ds_write_b128 v4, v[88:91] offset:0
    v_lshlrev_b32 v48, 16, v92
    v_and_b32 v49, 0xffff0000, v92
    v_lshlrev_b32 v50, 16, v93
    v_and_b32 v51, 0xffff0000, v93
    v_lshlrev_b32 v52, 16, v94
    v_and_b32 v53, 0xffff0000, v94
    v_lshlrev_b32 v54, 16, v95
    v_and_b32 v55, 0xffff0000, v95
    v_readfirstlane_b32 s77, v48
    s_nop 1
    v_subrev_f32 v56, s77, v48
    v_subrev_f32 v57, s77, v49
    v_subrev_f32 v58, s77, v50
    v_subrev_f32 v59, s77, v51
    v_subrev_f32 v60, s77, v52
    v_subrev_f32 v61, s77, v53
    v_subrev_f32 v62, s77, v54
    v_subrev_f32 v63, s77, v55
    v_add_f32 v64, v56, v57
    v_mul_f32 v65, v56, v56
    v_fmac_f32 v65, v57, v57
    v_add_f32 v64, v64, v58
    v_fmac_f32 v65, v58, v58
    v_add_f32 v64, v64, v59
    v_fmac_f32 v65, v59, v59
    v_add_f32 v64, v64, v60
    v_fmac_f32 v65, v60, v60
    v_add_f32 v64, v64, v61
    v_fmac_f32 v65, v61, v61
    v_add_f32 v64, v64, v62
    v_fmac_f32 v65, v62, v62
    v_add_f32 v64, v64, v63
    v_fmac_f32 v65, v63, v63
    s_nop 0
    v_add_f32_dpp v64, v64, v64 quad_perm:[1,0,3,2] row_mask:0xf bank_mask:0xf
    v_add_f32_dpp v65, v65, v65 quad_perm:[1,0,3,2] row_mask:0xf bank_mask:0xf
    s_nop 0
    v_add_f32_dpp v64, v64, v64 quad_perm:[2,3,0,1] row_mask:0xf bank_mask:0xf
    v_add_f32_dpp v65, v65, v65 quad_perm:[2,3,0,1] row_mask:0xf bank_mask:0xf
    s_nop 0
    v_add_f32_dpp v64, v64, v64 row_half_mirror row_mask:0xf bank_mask:0xf
    v_add_f32_dpp v65, v65, v65 row_half_mirror row_mask:0xf bank_mask:0xf
    s_nop 0
    v_add_f32_dpp v64, v64, v64 row_mirror row_mask:0xf bank_mask:0xf
    v_add_f32_dpp v65, v65, v65 row_mirror row_mask:0xf bank_mask:0xf
    v_mov_b32 v66, v64
    v_mov_b32 v67, v65
    s_nop 0
    v_permlane16_swap_b32 v64, v66
    v_permlane16_swap_b32 v65, v67
    v_add_f32 v64, v64, v66
    v_add_f32 v65, v65, v67
    v_mov_b32 v66, v64
    v_mov_b32 v67, v65
    s_nop 0
    v_permlane32_swap_b32 v64, v66
    v_permlane32_swap_b32 v65, v67
    v_add_f32 v64, v64, v66
    v_add_f32 v65, v65, v67
    v_mul_f32 v64, 0x3b000000, v64
    v_mul_f32 v65, 0x3b000000, v65
    v_fma_f32 v65, -v64, v64, v65
    v_max_f32 v65, 0, v65
    v_add_f32 v64, s77, v64
    v_cvt_pk_bf16_f32 v66, v64, v65
    v_lshlrev_b32 v64, 16, v66
    v_and_b32 v65, 0xffff0000, v66
    v_add_f32 v65, 0x3727c5ac, v65
    v_cvt_pk_bf16_f32 v66, v65, v65
    v_lshlrev_b32 v65, 16, v66
    v_sqrt_f32 v65, v65
    s_nop 0
    v_cvt_pk_bf16_f32 v66, v65, v65
    v_lshlrev_b32 v65, 16, v66
    v_rcp_f32 v65, v65
    v_sub_f32 v48, v48, v64
    v_sub_f32 v49, v49, v64
    v_sub_f32 v50, v50, v64
    v_sub_f32 v51, v51, v64
    v_sub_f32 v52, v52, v64
    v_sub_f32 v53, v53, v64
    v_sub_f32 v54, v54, v64
    v_sub_f32 v55, v55, v64
    v_cvt_pk_bf16_f32 v56, v48, v49
    v_lshlrev_b32 v48, 16, v56
    v_and_b32 v49, 0xffff0000, v56
    v_cvt_pk_bf16_f32 v57, v50, v51
    v_lshlrev_b32 v50, 16, v57
    v_and_b32 v51, 0xffff0000, v57
    v_cvt_pk_bf16_f32 v58, v52, v53
    v_lshlrev_b32 v52, 16, v58
    v_and_b32 v53, 0xffff0000, v58
    v_cvt_pk_bf16_f32 v59, v54, v55
    v_lshlrev_b32 v54, 16, v59
    v_and_b32 v55, 0xffff0000, v59
    v_mul_f32 v48, v48, v65
    v_mul_f32 v49, v49, v65
    v_mul_f32 v50, v50, v65
    v_mul_f32 v51, v51, v65
    v_mul_f32 v52, v52, v65
    v_mul_f32 v53, v53, v65
    v_mul_f32 v54, v54, v65
    v_mul_f32 v55, v55, v65
    v_cvt_pk_bf16_f32 v56, v48, v49
    v_lshlrev_b32 v48, 16, v56
    v_and_b32 v49, 0xffff0000, v56
    v_cvt_pk_bf16_f32 v57, v50, v51
    v_lshlrev_b32 v50, 16, v57
    v_and_b32 v51, 0xffff0000, v57
    v_cvt_pk_bf16_f32 v58, v52, v53
    v_lshlrev_b32 v52, 16, v58
    v_and_b32 v53, 0xffff0000, v58
    v_cvt_pk_bf16_f32 v59, v54, v55
    v_lshlrev_b32 v54, 16, v59
    v_and_b32 v55, 0xffff0000, v59
    v_cvt_pk_bf16_f32 v92, v48, v49
    v_cvt_pk_bf16_f32 v93, v50, v51
    v_cvt_pk_bf16_f32 v94, v52, v53
    v_cvt_pk_bf16_f32 v95, v54, v55
    ds_write_b128 v4, v[92:95] offset:1024
    s_waitcnt lgkmcnt(0)
    v_mov_b32 v5, 1
    s_mov_b64 exec, 1
    ds_add_u32 v3, v5 offset:20
    s_mov_b64 exec, -1
    s_branch L_VWAIT
L_C_S:
    s_mul_i32 s85, s74, 2112
    s_add_u32 s85, s85, 131072
    v_add_u32 v5, s85, v4
    s_waitcnt vmcnt(1)
    v_lshlrev_b32 v16, 16, v104
    v_and_b32 v17, 0xffff0000, v104
    v_lshlrev_b32 v18, 16, v105
    v_and_b32 v19, 0xffff0000, v105
    v_lshlrev_b32 v20, 16, v106
    v_and_b32 v21, 0xffff0000, v106
    v_lshlrev_b32 v22, 16, v107
    v_and_b32 v23, 0xffff0000, v107
    s_mov_b32 s77, 0xbfb8aa3b
    v_mul_f32 v24, s77, v16
    v_mul_f32 v25, s77, v17
    v_mul_f32 v26, s77, v18
    v_mul_f32 v27, s77, v19
    v_mul_f32 v28, s77, v20
    v_mul_f32 v29, s77, v21
    v_mul_f32 v30, s77, v22
    v_mul_f32 v31, s77, v23
    v_exp_f32 v24, v24
    v_exp_f32 v25, v25
    v_exp_f32 v26, v26
    v_exp_f32 v27, v27
    v_exp_f32 v28, v28
    v_exp_f32 v29, v29
    v_exp_f32 v30, v30
    v_exp_f32 v31, v31
    v_add_f32 v24, 1.0, v24
    v_add_f32 v25, 1.0, v25
    v_add_f32 v26, 1.0, v26
    v_add_f32 v27, 1.0, v27
    v_add_f32 v28, 1.0, v28
    v_add_f32 v29, 1.0, v29
    v_add_f32 v30, 1.0, v30
    v_add_f32 v31, 1.0, v31
    v_rcp_f32 v24, v24
    v_rcp_f32 v25, v25
    v_rcp_f32 v26, v26
    v_rcp_f32 v27, v27
    v_rcp_f32 v28, v28
    v_rcp_f32 v29, v29
    v_rcp_f32 v30, v30
    v_rcp_f32 v31, v31
    v_mul_f32 v16, v16, v24
    v_mul_f32 v17, v17, v25
    v_mul_f32 v18, v18, v26
    v_mul_f32 v19, v19, v27
    v_mul_f32 v20, v20, v28
    v_mul_f32 v21, v21, v29
    v_mul_f32 v22, v22, v30
    v_mul_f32 v23, v23, v31
    v_cvt_pk_bf16_f32 v104, v16, v17
    v_cvt_pk_bf16_f32 v105, v18, v19
    v_cvt_pk_bf16_f32 v106, v20, v21
    v_cvt_pk_bf16_f32 v107, v22, v23
    ds_write_b128 v5, v[104:107]
    s_waitcnt vmcnt(0)
    v_lshlrev_b32 v16, 16, v100
    v_and_b32 v17, 0xffff0000, v100
    v_lshlrev_b32 v18, 16, v101
    v_and_b32 v19, 0xffff0000, v101
    v_lshlrev_b32 v20, 16, v102
    v_and_b32 v21, 0xffff0000, v102
    v_lshlrev_b32 v22, 16, v103
    v_and_b32 v23, 0xffff0000, v103
    s_mov_b32 s77, 0xbfb8aa3b
    v_mul_f32 v24, s77, v16
    v_mul_f32 v25, s77, v17
    v_mul_f32 v26, s77, v18
    v_mul_f32 v27, s77, v19
    v_mul_f32 v28, s77, v20
    v_mul_f32 v29, s77, v21
    v_mul_f32 v30, s77, v22
    v_mul_f32 v31, s77, v23
    v_exp_f32 v24, v24
    v_exp_f32 v25, v25
    v_exp_f32 v26, v26
    v_exp_f32 v27, v27
    v_exp_f32 v28, v28
    v_exp_f32 v29, v29
    v_exp_f32 v30, v30
    v_exp_f32 v31, v31
    v_add_f32 v24, 1.0, v24
    v_add_f32 v25, 1.0, v25
    v_add_f32 v26, 1.0, v26
    v_add_f32 v27, 1.0, v27
    v_add_f32 v28, 1.0, v28
    v_add_f32 v29, 1.0, v29
    v_add_f32 v30, 1.0, v30
    v_add_f32 v31, 1.0, v31
    v_rcp_f32 v24, v24
    v_rcp_f32 v25, v25
    v_rcp_f32 v26, v26
    v_rcp_f32 v27, v27
    v_rcp_f32 v28, v28
    v_rcp_f32 v29, v29
    v_rcp_f32 v30, v30
    v_rcp_f32 v31, v31
    v_mul_f32 v16, v16, v24
    v_mul_f32 v17, v17, v25
    v_mul_f32 v18, v18, v26
    v_mul_f32 v19, v19, v27
    v_mul_f32 v20, v20, v28
    v_mul_f32 v21, v21, v29
    v_mul_f32 v22, v22, v30
    v_mul_f32 v23, v23, v31
    v_cvt_pk_bf16_f32 v100, v16, v17
    v_cvt_pk_bf16_f32 v101, v18, v19
    v_cvt_pk_bf16_f32 v102, v20, v21
    v_cvt_pk_bf16_f32 v103, v22, v23
    ds_write_b128 v5, v[100:103] offset:1056
    s_waitcnt lgkmcnt(0)
    v_mov_b32 v5, 1
    s_mov_b64 exec, 1
    ds_add_u32 v3, v5 offset:24
    s_mov_b64 exec, -1
    s_cmp_lg_u32 s3, 8
    s_cbranch_scc1 L_VWAIT
    s_setprio 3
SPIN_13:
    ds_read_b32 v15, v3 offset:12
    s_waitcnt lgkmcnt(0)
    v_readfirstlane_b32 s76, v15
    s_nop 0
    s_cmp_ge_u32 s76, 1
    s_cbranch_scc1 SPD_14
    s_cmp_eq_u32 s72, 0
    s_cbranch_scc1 SPD_14
    s_sub_u32 s72, s72, 1
    s_sleep 1
    s_branch SPIN_13
SPD_14:
    v_lshrrev_b32 v7, 4, v1
    v_lshlrev_b32 v5, 14, v7
    v_bfe_u32 v6, v1, 1, 3
    v_lshl_add_u32 v5, v6, 6, v5
    v_and_b32 v7, 1, v1
    v_lshl_add_u32 v5, v7, 4, v5
    s_lshr_b32 s80, s2, 1
    s_lshl_b32 s80, s80, 9
    s_and_b32 s81, s2, 1
    s_lshl_b32 s81, s81, 5
    s_add_u32 s80, s80, s81
    s_add_u32 s80, s80, 4718592
    s_add_u32 s81, s80, 0x10000
    s_add_u32 s82, s80, 131072
    s_add_u32 s83, s81, 131072
    v_lshlrev_b32 v6, 10, v6
    v_lshl_add_u32 v6, v7, 3, v6
    s_lshl_b32 s84, s2, 4
    s_add_u32 s84, s84, 81920
    v_add_u32 v6, s84, v6
    v_and_b32 v7, 15, v1
    v_lshlrev_b32 v8, 3, v7
    v_bfe_u32 v7, v1, 4, 1
    v_mul_u32_u24 v9, 8192, v7
    v_add_u32 v8, v8, v9
    v_mul_lo_u32 v9, v7, v15
    s_lshl_b32 s84, s2, 7
    s_add_u32 s84, s84, 3276800
SPIN_15:
    ds_read_b32 v7, v3 offset:20
    s_waitcnt lgkmcnt(0)
    v_readfirstlane_b32 s76, v7
    s_nop 0
    s_cmp_ge_u32 s76, 4
    s_cbranch_scc1 SPD_16
    s_cmp_eq_u32 s72, 0
    s_cbranch_scc1 SPD_16
    s_sub_u32 s72, s72, 1
    s_sleep 1
    s_branch SPIN_15
SPD_16:
    ds_read_b64 v[10:11], v6
SPIN_17:
    ds_read_b32 v7, v3 offset:24
    s_waitcnt lgkmcnt(0)
    v_readfirstlane_b32 s76, v7
    s_nop 0
    s_cmp_ge_u32 s76, 16
    s_cbranch_scc1 SPD_18
    s_cmp_eq_u32 s72, 0
    s_cbranch_scc1 SPD_18
    s_sub_u32 s72, s72, 1
    s_sleep 1
    s_branch SPIN_17
SPD_18:
XP_19:
    buffer_load_dwordx4 v[16:19], v5, s[16:19], s80 offen sc1
    buffer_load_dwordx4 v[20:23], v5, s[16:19], s81 offen sc1
    buffer_load_dwordx4 v[24:27], v5, s[16:19], s82 offen sc1
    buffer_load_dwordx4 v[28:31], v5, s[16:19], s83 offen sc1
    s_waitcnt vmcnt(0)
    v_xor_b32 v24, v24, v16
    v_xor_b32 v25, v25, v17
    v_xor_b32 v26, v26, v18
    v_xor_b32 v27, v27, v19
    v_xor_b32 v28, v28, v20
    v_xor_b32 v29, v29, v21
    v_xor_b32 v30, v30, v22
    v_xor_b32 v31, v31, v23
    v_xor_b32 v7, v24, v15
    v_bitop3_b32 v7, v7, v25, v15 bitop3:0xf6
    v_bitop3_b32 v7, v7, v26, v15 bitop3:0xf6
    v_bitop3_b32 v7, v7, v27, v15 bitop3:0xf6
    v_bitop3_b32 v7, v7, v28, v15 bitop3:0xf6
    v_bitop3_b32 v7, v7, v29, v15 bitop3:0xf6
    v_bitop3_b32 v7, v7, v30, v15 bitop3:0xf6
    v_bitop3_b32 v7, v7, v31, v15 bitop3:0xf6
    v_cmp_ne_u32 vcc, 0, v7
    s_cbranch_vccz XPD_20
    s_cmp_eq_u32 s72, 0
    s_cbranch_scc1 XPD_20
    s_sub_u32 s72, s72, 1
    s_sleep 2
    s_branch XP_19
XPD_20:
    v_add_f32 v16, v16, v20
    v_add_f32 v17, v17, v21
    v_add_f32 v18, v18, v22
    v_add_f32 v19, v19, v23
    v_mov_b32 v20, v16
    v_mov_b32 v21, v17
    v_mov_b32 v22, v18
    v_mov_b32 v23, v19
    v_permlane32_swap_b32 v16, v20
    v_permlane32_swap_b32 v17, v21
    v_permlane32_swap_b32 v18, v22
    v_permlane32_swap_b32 v19, v23
    v_add_f32 v16, v16, v20
    v_add_f32 v17, v17, v21
    v_add_f32 v18, v18, v22
    v_add_f32 v19, v19, v23
    v_cvt_pk_bf16_f32 v12, v16, v17
    v_lshlrev_b32 v16, 16, v12
    v_and_b32 v17, 0xffff0000, v12
    v_cvt_pk_bf16_f32 v13, v18, v19
    v_lshlrev_b32 v18, 16, v13
    v_and_b32 v19, 0xffff0000, v13
    v_mov_b32 v20, v16
    v_mov_b32 v21, v17
    v_mov_b32 v22, v18
    v_mov_b32 v23, v19
    v_permlane16_swap_b32 v16, v20
    v_permlane16_swap_b32 v17, v21
    v_permlane16_swap_b32 v18, v22
    v_permlane16_swap_b32 v19, v23
    v_add_f32 v20, 1.0, v20
    v_add_f32 v21, 1.0, v21
    v_add_f32 v22, 1.0, v22
    v_add_f32 v23, 1.0, v23
    v_cvt_pk_bf16_f32 v12, v20, v21
    v_lshlrev_b32 v20, 16, v12
    v_and_b32 v21, 0xffff0000, v12
    v_cvt_pk_bf16_f32 v13, v22, v23
    v_lshlrev_b32 v22, 16, v13
    v_and_b32 v23, 0xffff0000, v13
    v_lshlrev_b32 v24, 16, v10
    v_and_b32 v25, 0xffff0000, v10
    v_lshlrev_b32 v26, 16, v11
    v_and_b32 v27, 0xffff0000, v11
    v_mul_f32 v24, v24, v20
    v_mul_f32 v25, v25, v21
    v_mul_f32 v26, v26, v22
    v_mul_f32 v27, v27, v23
    v_cvt_pk_bf16_f32 v12, v24, v25
    v_lshlrev_b32 v24, 16, v12
    v_and_b32 v25, 0xffff0000, v12
    v_cvt_pk_bf16_f32 v13, v26, v27
    v_lshlrev_b32 v26, 16, v13
    v_and_b32 v27, 0xffff0000, v13
    v_add_f32 v24, v24, v16
    v_add_f32 v25, v25, v17
    v_add_f32 v26, v26, v18
    v_add_f32 v27, v27, v19
    v_cvt_pk_bf16_f32 v10, v24, v25
    v_cvt_pk_bf16_f32 v11, v26, v27
    v_xor_b32 v10, v10, v9
    v_xor_b32 v11, v11, v9
    s_mov_b32 exec_hi, 0
    buffer_store_dwordx2 v[10:11], v8, s[16:19], s84 offen sc1
    s_mov_b64 exec, -1
    v_mov_b32 v7, 1
    ds_write_b32 v3, v7 offset:40
    s_setprio 0
    s_branch L_VWAIT
L_C_MT:
    v_lshrrev_b32 v7, 2, v1
    v_mul_u32_u24 v12, 6144, v7
    v_and_b32 v7, 3, v1
    v_lshl_add_u32 v12, v7, 4, v12
    s_and_b32 s85, s3, 1
    s_mul_i32 s88, s85, 1572864
    s_lshl_b32 s89, s73, 6
    s_add_u32 s88, s88, s89
    s_add_u32 s88, s88, 2048
    s_lshl_b32 s89, s85, 14
    v_lshrrev_b32 v7, 4, v1
    v_lshlrev_b32 v6, 9, v7
    v_bfe_u32 v7, v1, 2, 2
    v_lshl_add_u32 v6, v7, 6, v6
    v_and_b32 v7, 3, v1
    v_lshl_add_u32 v6, v7, 3, v6
    s_lshl_b32 s84, s85, 5
    v_add_u32 v6, s84, v6
    v_and_b32 v7, 7, v1
    v_mul_u32_u24 v8, 1056, v7
    v_lshrrev_b32 v7, 4, v1
    v_lshl_add_u32 v8, v7, 4, v8
    v_add_u32 v8, 131072, v8
    v_and_b32 v7, 7, v1
    v_lshlrev_b32 v9, 12, v7
    v_lshrrev_b32 v7, 4, v1
    v_lshl_add_u32 v9, v7, 3, v9
    s_lshl_b32 s86, s73, 6
    s_add_u32 s86, s86, s84
    s_add_u32 s86, s86, 4194304
SPIN_21:
    ds_read_b32 v7, v3 offset:40
    s_waitcnt lgkmcnt(0)
    v_readfirstlane_b32 s76, v7
    s_nop 0
    s_cmp_ge_u32 s76, 1
    s_cbranch_scc1 SPD_22
    s_cmp_eq_u32 s72, 0
    s_cbranch_scc1 SPD_22
    s_sub_u32 s72, s72, 1
    s_sleep 2
    s_branch SPIN_21
SPD_22:
    s_setprio 1
    s_add_u32 s78, s88, 0
    s_add_u32 m0, s89, 0
    s_nop 0
    buffer_load_dwordx4 v12, s[24:27], s78 offen nt lds
    s_add_u32 s78, s88, 98304
    s_add_u32 m0, s89, 1024
    s_nop 0
    buffer_load_dwordx4 v12, s[24:27], s78 offen nt lds
    s_add_u32 s78, s88, 196608
    s_add_u32 m0, s89, 2048
    s_nop 0
    buffer_load_dwordx4 v12, s[24:27], s78 offen nt lds
    s_add_u32 s78, s88, 294912
    s_add_u32 m0, s89, 3072
    s_nop 0
    buffer_load_dwordx4 v12, s[24:27], s78 offen nt lds
    s_add_u32 s78, s88, 393216
    s_add_u32 m0, s89, 4096
    s_nop 0
    buffer_load_dwordx4 v12, s[24:27], s78 offen nt lds
    s_add_u32 s78, s88, 491520
    s_add_u32 m0, s89, 5120
    s_nop 0
    buffer_load_dwordx4 v12, s[24:27], s78 offen nt lds
    s_add_u32 s78, s88, 589824
    s_add_u32 m0, s89, 6144
    s_nop 0
    buffer_load_dwordx4 v12, s[24:27], s78 offen nt lds
    s_add_u32 s78, s88, 688128
    s_add_u32 m0, s89, 7168
    s_nop 0
    buffer_load_dwordx4 v12, s[24:27], s78 offen nt lds
    s_add_u32 s78, s88, 786432
    s_add_u32 m0, s89, 8192
    s_nop 0
    buffer_load_dwordx4 v12, s[24:27], s78 offen nt lds
    s_add_u32 s78, s88, 884736
    s_add_u32 m0, s89, 9216
    s_nop 0
    buffer_load_dwordx4 v12, s[24:27], s78 offen nt lds
    s_add_u32 s78, s88, 983040
    s_add_u32 m0, s89, 10240
    s_nop 0
    buffer_load_dwordx4 v12, s[24:27], s78 offen nt lds
    s_add_u32 s78, s88, 1081344
    s_add_u32 m0, s89, 11264
    s_nop 0
    buffer_load_dwordx4 v12, s[24:27], s78 offen nt lds
    s_add_u32 s78, s88, 1179648
    s_add_u32 m0, s89, 12288
    s_nop 0
    buffer_load_dwordx4 v12, s[24:27], s78 offen nt lds
    s_add_u32 s78, s88, 1277952
    s_add_u32 m0, s89, 13312
    s_nop 0
    buffer_load_dwordx4 v12, s[24:27], s78 offen nt lds
    s_add_u32 s78, s88, 1376256
    s_add_u32 m0, s89, 14336
    s_nop 0
    buffer_load_dwordx4 v12, s[24:27], s78 offen nt lds
    s_add_u32 s78, s88, 1474560
    s_add_u32 m0, s89, 15360
    s_nop 0
    buffer_load_dwordx4 v12, s[24:27], s78 offen nt lds
    v_mov_b32 v7, 1
    s_mov_b64 exec, 1
    ds_add_u32 v3, v7 offset:44
    s_mov_b64 exec, -1
SPIN_23:
    ds_read_b32 v10, v3 offset:12
    s_waitcnt lgkmcnt(0)
    v_readfirstlane_b32 s76, v10
    s_nop 0
    s_cmp_ge_u32 s76, 1
    s_cbranch_scc1 SPD_24
    s_cmp_eq_u32 s72, 0
    s_cbranch_scc1 SPD_24
    s_sub_u32 s72, s72, 1
    s_sleep 1
    s_branch SPIN_23
SPD_24:
    s_mov_b32 vcc_lo, 0xff00ff00
    s_mov_b32 vcc_hi, 0xff00ff00
    v_mov_b32 v7, 131072
    v_cndmask_b32 v7, 0, v7, vcc
    v_add_u32 v9, v9, v7
    v_cndmask_b32 v10, 0, v10, vcc
    s_waitcnt vmcnt(0)
    v_mov_b32 v7, 1
    s_mov_b64 exec, 1
    ds_add_u32 v3, v7 offset:16
    s_mov_b64 exec, -1
SPIN_25:
    ds_read_b32 v7, v3 offset:16
    s_waitcnt lgkmcnt(0)
    v_readfirstlane_b32 s76, v7
    s_nop 0
    s_cmp_ge_u32 s76, 2
    s_cbranch_scc1 SPD_26
    s_cmp_eq_u32 s72, 0
    s_cbranch_scc1 SPD_26
    s_sub_u32 s72, s72, 1
    s_sleep 1
    s_branch SPIN_25
SPD_26:
SPIN_27:
    ds_read_b32 v7, v3 offset:24
    s_waitcnt lgkmcnt(0)
    v_readfirstlane_b32 s76, v7
    s_nop 0
    s_cmp_ge_u32 s76, 12
    s_cbranch_scc1 SPD_28
    s_cmp_eq_u32 s72, 0
    s_cbranch_scc1 SPD_28
    s_sub_u32 s72, s72, 1
    s_sleep 1
    s_branch SPIN_27
SPD_28:
    ds_read_b64_tr_b16 v[32:33], v6 offset:0
    ds_read_b64_tr_b16 v[34:35], v6 offset:256
    ds_read_b128 v[64:67], v8 offset:0
    ds_read_b64_tr_b16 v[36:37], v6 offset:2048
    ds_read_b64_tr_b16 v[38:39], v6 offset:2304
    ds_read_b128 v[68:71], v8 offset:64
    ds_read_b64_tr_b16 v[40:41], v6 offset:4096
    ds_read_b64_tr_b16 v[42:43], v6 offset:4352
    ds_read_b128 v[72:75], v8 offset:128
    ds_read_b64_tr_b16 v[44:45], v6 offset:6144
    ds_read_b64_tr_b16 v[46:47], v6 offset:6400
    ds_read_b128 v[76:79], v8 offset:192
    ds_read_b64_tr_b16 v[48:49], v6 offset:8192
    ds_read_b64_tr_b16 v[50:51], v6 offset:8448
    ds_read_b128 v[80:83], v8 offset:256
    ds_read_b64_tr_b16 v[52:53], v6 offset:10240
    ds_read_b64_tr_b16 v[54:55], v6 offset:10496
    ds_read_b128 v[84:87], v8 offset:320
    ds_read_b64_tr_b16 v[56:57], v6 offset:12288
    ds_read_b64_tr_b16 v[58:59], v6 offset:12544
    ds_read_b128 v[88:91], v8 offset:384
    ds_read_b64_tr_b16 v[60:61], v6 offset:14336
    ds_read_b64_tr_b16 v[62:63], v6 offset:14592
    ds_read_b128 v[92:95], v8 offset:448
    s_waitcnt lgkmcnt(12)
    v_mfma_f32_16x16x32_bf16 v[12:15], v[32:35], v[64:67], 0
    v_mfma_f32_16x16x32_bf16 v[12:15], v[36:39], v[68:71], v[12:15]
    v_mfma_f32_16x16x32_bf16 v[12:15], v[40:43], v[72:75], v[12:15]
    v_mfma_f32_16x16x32_bf16 v[12:15], v[44:47], v[76:79], v[12:15]
    ds_read_b64_tr_b16 v[32:33], v6 offset:16384
    ds_read_b64_tr_b16 v[34:35], v6 offset:16640
    ds_read_b128 v[64:67], v8 offset:512
    ds_read_b64_tr_b16 v[36:37], v6 offset:18432
    ds_read_b64_tr_b16 v[38:39], v6 offset:18688
    ds_read_b128 v[68:71], v8 offset:576
    ds_read_b64_tr_b16 v[40:41], v6 offset:20480
    ds_read_b64_tr_b16 v[42:43], v6 offset:20736
    ds_read_b128 v[72:75], v8 offset:640
    ds_read_b64_tr_b16 v[44:45], v6 offset:22528
    ds_read_b64_tr_b16 v[46:47], v6 offset:22784
    ds_read_b128 v[76:79], v8 offset:704
    s_waitcnt lgkmcnt(12)
    v_mfma_f32_16x16x32_bf16 v[12:15], v[48:51], v[80:83], v[12:15]
    v_mfma_f32_16x16x32_bf16 v[12:15], v[52:55], v[84:87], v[12:15]
    v_mfma_f32_16x16x32_bf16 v[12:15], v[56:59], v[88:91], v[12:15]
    v_mfma_f32_16x16x32_bf16 v[12:15], v[60:63], v[92:95], v[12:15]
    ds_read_b64_tr_b16 v[48:49], v6 offset:24576
    ds_read_b64_tr_b16 v[50:51], v6 offset:24832
    ds_read_b128 v[80:83], v8 offset:768
    ds_read_b64_tr_b16 v[52:53], v6 offset:26624
    ds_read_b64_tr_b16 v[54:55], v6 offset:26880
    ds_read_b128 v[84:87], v8 offset:832
    ds_read_b64_tr_b16 v[56:57], v6 offset:28672
    ds_read_b64_tr_b16 v[58:59], v6 offset:28928
    ds_read_b128 v[88:91], v8 offset:896
    ds_read_b64_tr_b16 v[60:61], v6 offset:30720
    ds_read_b64_tr_b16 v[62:63], v6 offset:30976
    ds_read_b128 v[92:95], v8 offset:960
    s_waitcnt lgkmcnt(12)
    v_mfma_f32_16x16x32_bf16 v[12:15], v[32:35], v[64:67], v[12:15]
    v_mfma_f32_16x16x32_bf16 v[12:15], v[36:39], v[68:71], v[12:15]
    v_mfma_f32_16x16x32_bf16 v[12:15], v[40:43], v[72:75], v[12:15]
    v_mfma_f32_16x16x32_bf16 v[12:15], v[44:47], v[76:79], v[12:15]
    s_waitcnt lgkmcnt(0)
    v_mfma_f32_16x16x32_bf16 v[12:15], v[48:51], v[80:83], v[12:15]
    v_mfma_f32_16x16x32_bf16 v[12:15], v[52:55], v[84:87], v[12:15]
    v_mfma_f32_16x16x32_bf16 v[12:15], v[56:59], v[88:91], v[12:15]
    v_mfma_f32_16x16x32_bf16 v[12:15], v[60:63], v[92:95], v[12:15]
    s_nop 7
    v_cvt_pk_bf16_f32 v100, v12, v13
    v_cvt_pk_bf16_f32 v101, v14, v15
    v_xor_b32 v100, v100, v10
    v_xor_b32 v101, v101, v10
    buffer_store_dwordx2 v[100:101], v9, s[16:19], s86 offen sc1
    s_setprio 0
    s_branch L_VW_C
L_TD:
    s_cmp_ge_u32 s3, 12
    s_cbranch_scc1 L_VWAIT
    s_cmp_ge_u32 s3, 8
    s_cbranch_scc1 L_D_H
    v_lshrrev_b32 v14, 3, v1
    s_mov_b32 s77, 8192
    v_mul_lo_u32 v12, v14, s77
    v_bfe_u32 v14, v1, 4, 1
    v_lshlrev_b32 v14, 1, v14
    v_and_b32 v13, 7, v1
    v_xor_b32 v14, v14, v13
    v_lshlrev_b32 v14, 4, v14
    v_add_u32 v12, v12, v14
    v_xor_b32 v13, 64, v12
    s_lshl_b32 s85, s3, 13
    s_lshl_b32 s84, s3, 19
    s_lshl_b32 s86, s73, 7
    s_add_u32 s84, s84, s86
    s_add_u32 s78, s84, 0
    s_add_u32 m0, s85, 0
    s_nop 0
    buffer_load_dwordx4 v12, s[20:23], s78 offen nt lds
    s_add_u32 s78, s84, 65536
    s_add_u32 m0, s85, 1024
    s_nop 0
    buffer_load_dwordx4 v13, s[20:23], s78 offen nt lds
    s_add_u32 s78, s84, 131072
    s_add_u32 m0, s85, 2048
    s_nop 0
    buffer_load_dwordx4 v12, s[20:23], s78 offen nt lds
    s_add_u32 s78, s84, 196608
    s_add_u32 m0, s85, 3072
    s_nop 0
    buffer_load_dwordx4 v13, s[20:23], s78 offen nt lds
    s_add_u32 s78, s84, 262144
    s_add_u32 m0, s85, 4096
    s_nop 0
    buffer_load_dwordx4 v12, s[20:23], s78 offen nt lds
    s_add_u32 s78, s84, 327680
    s_add_u32 m0, s85, 5120
    s_nop 0
    buffer_load_dwordx4 v13, s[20:23], s78 offen nt lds
    s_add_u32 s78, s84, 393216
    s_add_u32 m0, s85, 6144
    s_nop 0
    buffer_load_dwordx4 v12, s[20:23], s78 offen nt lds
    s_add_u32 s78, s84, 458752
    s_add_u32 m0, s85, 7168
    s_nop 0
    buffer_load_dwordx4 v13, s[20:23], s78 offen nt lds
    v_mov_b32 v7, 1
    s_mov_b64 exec, 1
    ds_add_u32 v3, v7 offset:44
    s_mov_b64 exec, -1
    s_waitcnt vmcnt(0)
    v_mov_b32 v7, 1
    s_mov_b64 exec, 1
    ds_add_u32 v3, v7 offset:16
    s_mov_b64 exec, -1
    s_cmp_ge_u32 s3, 4
    s_cbranch_scc1 L_VWAIT
    v_lshrrev_b32 v6, 4, v1
    v_lshlrev_b32 v5, 10, v6
    v_and_b32 v6, 1, v6
    v_lshlrev_b32 v6, 1, v6
    v_bfe_u32 v7, v1, 3, 1
    v_or_b32 v6, v6, v7
    v_xor_b32 v6, s3, v6
    v_lshl_add_u32 v5, v6, 5, v5
    v_bfe_u32 v6, v1, 2, 2
    v_lshl_add_u32 v5, v6, 7, v5
    v_and_b32 v6, 3, v1
    v_lshl_add_u32 v5, v6, 3, v5
    v_add_u32 v5, 0, v5
    v_and_b32 v7, 7, v1
    v_mul_u32_u24 v6, 1056, v7
    v_lshrrev_b32 v7, 4, v1
    v_lshl_add_u32 v6, v7, 4, v6
    v_add_u32 v6, 98304, v6
    s_lshl_b32 s86, s73, 10
    s_lshl_b32 s84, s3, 5
    s_add_u32 s86, s86, s84
    s_add_u32 s86, s86, 3145728
    v_and_b32 v7, 7, v1
    v_lshlrev_b32 v4, 7, v7
    v_lshrrev_b32 v7, 4, v1
    v_lshl_add_u32 v4, v7, 3, v4
SPIN_29:
    ds_read_b32 v12, v3 offset:12
    s_waitcnt lgkmcnt(0)
    v_readfirstlane_b32 s76, v12
    s_nop 0
    s_cmp_ge_u32 s76, 1
    s_cbranch_scc1 SPD_30
    s_cmp_eq_u32 s72, 0
    s_cbranch_scc1 SPD_30
    s_sub_u32 s72, s72, 1
    s_sleep 1
    s_branch SPIN_29
SPD_30:
    s_mov_b32 vcc_lo, 0xff00ff00
    s_mov_b32 vcc_hi, 0xff00ff00
    v_mov_b32 v7, 65536
    v_cndmask_b32 v7, 0, v7, vcc
    v_add_u32 v4, v4, v7
    v_cndmask_b32 v12, 0, v12, vcc
SPIN_31:
    ds_read_b32 v7, v3 offset:16
    s_waitcnt lgkmcnt(0)
    v_readfirstlane_b32 s76, v7
    s_nop 0
    s_cmp_ge_u32 s76, 8
    s_cbranch_scc1 SPD_32
    s_cmp_eq_u32 s72, 0
    s_cbranch_scc1 SPD_32
    s_sub_u32 s72, s72, 1
    s_sleep 1
    s_branch SPIN_31
SPD_32:
    ds_read_b64_tr_b16 v[16:17], v5 offset:0
    ds_read_b64_tr_b16 v[18:19], v5 offset:512
    ds_read_b64_tr_b16 v[20:21], v5 offset:4096
    ds_read_b64_tr_b16 v[22:23], v5 offset:4608
    ds_read_b64_tr_b16 v[24:25], v5 offset:8192
    ds_read_b64_tr_b16 v[26:27], v5 offset:8704
    ds_read_b64_tr_b16 v[28:29], v5 offset:12288
    ds_read_b64_tr_b16 v[30:31], v5 offset:12800
    ds_read_b64_tr_b16 v[32:33], v5 offset:16384
    ds_read_b64_tr_b16 v[34:35], v5 offset:16896
    ds_read_b64_tr_b16 v[36:37], v5 offset:20480
    ds_read_b64_tr_b16 v[38:39], v5 offset:20992
    ds_read_b64_tr_b16 v[40:41], v5 offset:24576
    ds_read_b64_tr_b16 v[42:43], v5 offset:25088
    ds_read_b64_tr_b16 v[44:45], v5 offset:28672
    ds_read_b64_tr_b16 v[46:47], v5 offset:29184
    ds_read_b64_tr_b16 v[48:49], v5 offset:32768
    ds_read_b64_tr_b16 v[50:51], v5 offset:33280
    ds_read_b64_tr_b16 v[52:53], v5 offset:36864
    ds_read_b64_tr_b16 v[54:55], v5 offset:37376
    ds_read_b64_tr_b16 v[56:57], v5 offset:40960
    ds_read_b64_tr_b16 v[58:59], v5 offset:41472
    ds_read_b64_tr_b16 v[60:61], v5 offset:45056
    ds_read_b64_tr_b16 v[62:63], v5 offset:45568
    ds_read_b64_tr_b16 v[64:65], v5 offset:49152
    ds_read_b64_tr_b16 v[66:67], v5 offset:49664
    ds_read_b64_tr_b16 v[68:69], v5 offset:53248
    ds_read_b64_tr_b16 v[70:71], v5 offset:53760
    ds_read_b64_tr_b16 v[72:73], v5 offset:57344
    ds_read_b64_tr_b16 v[74:75], v5 offset:57856
    ds_read_b64_tr_b16 v[76:77], v5 offset:61440
    ds_read_b64_tr_b16 v[78:79], v5 offset:61952
SPIN_33:
    ds_read_b32 v7, v3 offset:36
    s_waitcnt lgkmcnt(0)
    v_readfirstlane_b32 s76, v7
    s_nop 0
    s_cmp_ge_u32 s76, 1
    s_cbranch_scc1 SPD_34
    s_cmp_eq_u32 s72, 0
    s_cbranch_scc1 SPD_34
    s_sub_u32 s72, s72, 1
    s_sleep 1
    s_branch SPIN_33
SPD_34:
    ds_read_b32 v7, v3 offset:8
    s_waitcnt lgkmcnt(0)
    v_readfirstlane_b32 s7, v7
    s_nop 0
    s_cmp_eq_u32 s7, 1
    s_cselect_b64 s[92:93], s[58:59], s[100:101]
    s_setprio 3
SPIN_35:
    ds_read_b32 v7, v3 offset:28
    s_waitcnt lgkmcnt(0)
    v_readfirstlane_b32 s76, v7
    s_nop 0
    s_cmp_ge_u32 s76, 4
    s_cbranch_scc1 SPD_36
    s_cmp_eq_u32 s72, 0
    s_cbranch_scc1 SPD_36
    s_sub_u32 s72, s72, 1
    s_branch SPIN_35
SPD_36:
    ds_read_b128 v[80:83], v6 offset:0
    ds_read_b128 v[84:87], v6 offset:64
    ds_read_b128 v[88:91], v6 offset:128
    ds_read_b128 v[92:95], v6 offset:192
    ds_read_b128 v[96:99], v6 offset:256
    ds_read_b128 v[100:103], v6 offset:320
    ds_read_b128 v[104:107], v6 offset:384
    ds_read_b128 v[108:111], v6 offset:448
    s_waitcnt lgkmcnt(7)
    v_mfma_f32_16x16x32_bf16 v[8:11], v[16:19], v[80:83], 0
    s_waitcnt lgkmcnt(6)
    v_mfma_f32_16x16x32_bf16 v[8:11], v[20:23], v[84:87], v[8:11]
    s_waitcnt lgkmcnt(5)
    v_mfma_f32_16x16x32_bf16 v[8:11], v[24:27], v[88:91], v[8:11]
    s_waitcnt lgkmcnt(4)
    v_mfma_f32_16x16x32_bf16 v[8:11], v[28:31], v[92:95], v[8:11]
    ds_read_b128 v[80:83], v6 offset:512
    ds_read_b128 v[84:87], v6 offset:576
    ds_read_b128 v[88:91], v6 offset:640
    ds_read_b128 v[92:95], v6 offset:704
    s_waitcnt lgkmcnt(7)
    v_mfma_f32_16x16x32_bf16 v[8:11], v[32:35], v[96:99], v[8:11]
    s_waitcnt lgkmcnt(6)
    v_mfma_f32_16x16x32_bf16 v[8:11], v[36:39], v[100:103], v[8:11]
    s_waitcnt lgkmcnt(5)
    v_mfma_f32_16x16x32_bf16 v[8:11], v[40:43], v[104:107], v[8:11]
    s_waitcnt lgkmcnt(4)
    v_mfma_f32_16x16x32_bf16 v[8:11], v[44:47], v[108:111], v[8:11]
    ds_read_b128 v[96:99], v6 offset:768
    ds_read_b128 v[100:103], v6 offset:832
    ds_read_b128 v[104:107], v6 offset:896
    ds_read_b128 v[108:111], v6 offset:960
    s_waitcnt lgkmcnt(7)
    v_mfma_f32_16x16x32_bf16 v[8:11], v[48:51], v[80:83], v[8:11]
    s_waitcnt lgkmcnt(6)
    v_mfma_f32_16x16x32_bf16 v[8:11], v[52:55], v[84:87], v[8:11]
    s_waitcnt lgkmcnt(5)
    v_mfma_f32_16x16x32_bf16 v[8:11], v[56:59], v[88:91], v[8:11]
    s_waitcnt lgkmcnt(4)
    v_mfma_f32_16x16x32_bf16 v[8:11], v[60:63], v[92:95], v[8:11]
    s_waitcnt lgkmcnt(3)
    v_mfma_f32_16x16x32_bf16 v[8:11], v[64:67], v[96:99], v[8:11]
    s_waitcnt lgkmcnt(2)
    v_mfma_f32_16x16x32_bf16 v[8:11], v[68:71], v[100:103], v[8:11]
    s_waitcnt lgkmcnt(1)
    v_mfma_f32_16x16x32_bf16 v[8:11], v[72:75], v[104:107], v[8:11]
    s_waitcnt lgkmcnt(0)
    v_mfma_f32_16x16x32_bf16 v[8:11], v[76:79], v[108:111], v[8:11]
    s_nop 7
    v_cvt_pk_bf16_f32 v14, v8, v9
    v_cvt_pk_bf16_f32 v15, v10, v11
    v_xor_b32 v14, v14, v12
    v_xor_b32 v15, v15, v12
    s_cmp_eq_u32 s7, 1
    s_cbranch_scc1 PUBL_37
    buffer_store_dwordx2 v[14:15], v4, s[16:19], s86 offen sc1
    s_branch PUBD_38
PUBL_37:
    buffer_store_dwordx2 v[14:15], v4, s[16:19], s86 offen
PUBD_38:
    v_mov_b32 v7, 1
    s_mov_b64 exec, 1
    ds_add_u32 v3, v7 offset:48
    s_mov_b64 exec, -1
    s_setprio 0
    s_branch L_VWAIT
L_D_H:
    s_setprio 3
    v_lshlrev_b32 v4, 4, v1
    s_lshl_b32 s80, s74, 11
    s_add_u32 s81, s80, 3284992
    s_add_u32 s80, s80, 3276800
    v_and_b32 v7, 7, v1
    v_mul_u32_u24 v6, 1056, v7
    v_lshrrev_b32 v7, 3, v1
    v_lshl_add_u32 v6, v7, 4, v6
    s_lshl_b32 s84, s74, 8
    s_add_u32 s84, s84, 98304
    v_add_u32 v6, s84, v6
SPIN_39:
    ds_read_b32 v15, v3 offset:12
    s_waitcnt lgkmcnt(0)
    v_readfirstlane_b32 s76, v15
    s_nop 0
    s_cmp_ge_u32 s76, 1
    s_cbranch_scc1 SPD_40
    s_cmp_eq_u32 s72, 0
    s_cbranch_scc1 SPD_40
    s_sub_u32 s72, s72, 1
    s_sleep 1
    s_branch SPIN_39
SPD_40:
SPIN_41:
    ds_read_b32 v7, v3 offset:16
    s_waitcnt lgkmcnt(0)
    v_readfirstlane_b32 s76, v7
    s_nop 0
    s_cmp_ge_u32 s76, 8
    s_cbranch_scc1 SPD_42
    s_cmp_eq_u32 s72, 0
    s_cbranch_scc1 SPD_42
    s_sub_u32 s72, s72, 1
    s_sleep 1
    s_branch SPIN_41
SPD_42:
XP_43:
    buffer_load_dwordx4 v[16:19], v4, s[16:19], s80 offen sc1
    buffer_load_dwordx4 v[20:23], v4, s[16:19], s80 offen offset:1024 sc1
    buffer_load_dwordx4 v[24:27], v4, s[16:19], s81 offen sc1
    buffer_load_dwordx4 v[28:31], v4, s[16:19], s81 offen offset:1024 sc1
    s_waitcnt vmcnt(0)
    v_xor_b32 v24, v24, v16
    v_xor_b32 v25, v25, v17
    v_xor_b32 v26, v26, v18
    v_xor_b32 v27, v27, v19
    v_xor_b32 v28, v28, v20
    v_xor_b32 v29, v29, v21
    v_xor_b32 v30, v30, v22
    v_xor_b32 v31, v31, v23
    v_xor_b32 v7, v24, v15
    v_bitop3_b32 v7, v7, v25, v15 bitop3:0xf6
    v_bitop3_b32 v7, v7, v26, v15 bitop3:0xf6
    v_bitop3_b32 v7, v7, v27, v15 bitop3:0xf6
    v_bitop3_b32 v7, v7, v28, v15 bitop3:0xf6
    v_bitop3_b32 v7, v7, v29, v15 bitop3:0xf6
    v_bitop3_b32 v7, v7, v30, v15 bitop3:0xf6
    v_bitop3_b32 v7, v7, v31, v15 bitop3:0xf6
    v_cmp_ne_u32 vcc, 0, v7
    s_cbranch_vccz XPD_44
    s_cmp_eq_u32 s72, 0
    s_cbranch_scc1 XPD_44
    s_sub_u32 s72, s72, 1
    s_sleep 2
    s_branch XP_43
XPD_44:
    ds_write_b128 v6, v[16:19]
    ds_write_b128 v6, v[20:23] offset:128
    s_waitcnt lgkmcnt(0)
    v_mov_b32 v5, 1
    s_mov_b64 exec, 1
    ds_add_u32 v3, v5 offset:28
    s_mov_b64 exec, -1
    s_setprio 0
L_VWAIT:
    s_cmp_eq_u32 s6, 1
    s_cbranch_scc1 L_VW_D
SPIN_45:
    ds_read_b32 v7, v3 offset:40
    s_waitcnt lgkmcnt(0)
    v_readfirstlane_b32 s76, v7
    s_nop 0
    s_cmp_ge_u32 s76, 1
    s_cbranch_scc1 SPD_46
    s_cmp_eq_u32 s72, 0
    s_cbranch_scc1 SPD_46
    s_sub_u32 s72, s72, 1
    s_sleep 2
    s_branch SPIN_45
SPD_46:
SPIN_47:
    ds_read_b32 v7, v3 offset:44
    s_waitcnt lgkmcnt(0)
    v_readfirstlane_b32 s76, v7
    s_nop 0
    s_cmp_ge_u32 s76, 2
    s_cbranch_scc1 SPD_48
    s_cmp_eq_u32 s72, 0
    s_cbranch_scc1 SPD_48
    s_sub_u32 s72, s72, 1
    s_sleep 1
    s_branch SPIN_47
SPD_48:
L_VW_C:
    s_mov_b32 s80, 65535
    s_lshr_b32 s80, s80, s3
    s_bitcmp1_b32 s80, 0
    s_cbranch_scc1 L_VPATH
    s_cmp_lg_u32 s3, 9
    s_cbranch_scc1 L_VW_D2
SPIN_49:
    ds_read_b32 v12, v3 offset:12
    s_waitcnt lgkmcnt(0)
    v_readfirstlane_b32 s76, v12
    s_nop 0
    s_cmp_ge_u32 s76, 1
    s_cbranch_scc1 SPD_50
    s_cmp_eq_u32 s72, 0
    s_cbranch_scc1 SPD_50
    s_sub_u32 s72, s72, 1
    s_sleep 1
    s_branch SPIN_49
SPD_50:
    s_lshl_b32 s80, s73, 10
    s_add_u32 s80, s80, 3145728
    s_add_u32 s81, s80, 65536
    v_mov_b32 v5, 0
XP_51:
    buffer_load_dword v16, v5, s[16:19], s80 offen sc1
    buffer_load_dword v17, v5, s[16:19], s81 offen sc1
    s_waitcnt vmcnt(0)
    v_xor_b32 v17, v17, v16
    v_xor_b32 v7, v17, v12
    v_cmp_ne_u32 vcc, 0, v7
    s_cbranch_vccz XPD_52
    s_cmp_eq_u32 s72, 0
    s_cbranch_scc1 XPD_52
    s_sub_u32 s72, s72, 1
    s_sleep 4
    s_branch XP_51
XPD_52:
    v_mov_b32 v7, 4
    ds_write_b32 v3, v7 offset:48
    s_branch L_VPATH
L_VW_D:
    s_mov_b32 s80, 240
    s_lshr_b32 s80, s80, s3
    s_bitcmp1_b32 s80, 0
    s_cbranch_scc0 L_VW_D2
SPIN_53:
    ds_read_b32 v7, v3 offset:44
    s_waitcnt lgkmcnt(0)
    v_readfirstlane_b32 s76, v7
    s_nop 0
    s_cmp_ge_u32 s76, 8
    s_cbranch_scc1 SPD_54
    s_cmp_eq_u32 s72, 0
    s_cbranch_scc1 SPD_54
    s_sub_u32 s72, s72, 1
    s_sleep 1
    s_branch SPIN_53
SPD_54:
    s_branch L_VPATH
L_VW_D2:
SPIN_55:
    ds_read_b32 v7, v3 offset:48
    s_waitcnt lgkmcnt(0)
    v_readfirstlane_b32 s76, v7
    s_nop 0
    s_cmp_ge_u32 s76, 4
    s_cbranch_scc1 SPD_56
    s_cmp_eq_u32 s72, 0
    s_cbranch_scc1 SPD_56
    s_sub_u32 s72, s72, 1
    s_sleep 2
    s_branch SPIN_55
SPD_56:
L_VPATH:
    v_lshrrev_b32 v5, 3, v1
    v_lshlrev_b32 v2, 11, v5
    v_and_b32 v5, 7, v1
    v_lshl_add_u32 v2, v5, 4, v2
    s_mov_b32 s80, 0x76543210
    s_mov_b32 s81, 0xfedcba98
    s_mov_b32 s82, 0x76543210
    s_mov_b32 s83, 0xfedcba98
    s_cmp_eq_u32 s6, 1
    s_cselect_b64 s[80:81], s[82:83], s[80:81]
    s_lshl_b32 s82, s3, 2
    s_lshr_b64 s[80:81], s[80:81], s82
    s_and_b32 s87, s80, 15
    s_lshl_b32 s80, s87, 15
    s_lshl_b32 s81, s6, 7
    s_add_u32 s80, s80, s81
    s_add_u32 s81, s80, 16384
    s_mov_b32 s88, 0x05040100
    s_mov_b32 s89, 0x07060302
    v_and_b32 v7, 15, v1
    v_lshlrev_b32 v6, 4, v7
    v_lshrrev_b32 v7, 5, v1
    v_lshl_add_u32 v6, v7, 8, v6
    s_mul_i32 s84, s3, 2112
    s_add_u32 s84, s84, 90112
    v_add_u32 v6, s84, v6
    v_lshrrev_b32 v5, 3, v1
    v_mul_u32_u24 v120, 4224, v5
    v_and_b32 v5, 7, v1
    v_lshl_add_u32 v120, v5, 4, v120
    s_lshl_b32 s85, s74, 8
    s_add_u32 s84, s85, 90112
    v_add_u32 v120, s84, v120
    v_lshlrev_b32 v121, 3, v1
    s_lshl_b32 s86, s73, 10
    s_lshr_b32 s85, s85, 2
    s_add_u32 s86, s86, s85
    s_lshl_b32 s85, s6, 9
    s_add_u32 s86, s86, s85
    s_add_u32 s86, s86, 1048576
    v_lshrrev_b32 v7, 4, v1
    v_lshlrev_b32 v4, 7, v7
    v_and_b32 v7, 7, v1
    v_lshl_add_u32 v4, v7, 4, v4
    s_lshl_b32 s84, s73, 14
    s_lshl_b32 s85, s87, 10
    s_add_u32 s84, s84, s85
    buffer_load_dwordx4 v[8:11], v2, s[8:11], s80 offen offset:0 nt
    buffer_load_dwordx4 v[12:15], v2, s[8:11], s80 offen offset:256 nt
    buffer_load_dwordx4 v[16:19], v2, s[8:11], s80 offen offset:512 nt
    buffer_load_dwordx4 v[20:23], v2, s[8:11], s80 offen offset:768 nt
    buffer_load_dwordx4 v[24:27], v2, s[8:11], s80 offen offset:1024 nt
    buffer_load_dwordx4 v[28:31], v2, s[8:11], s80 offen offset:1280 nt
    buffer_load_dwordx4 v[32:35], v2, s[8:11], s80 offen offset:1536 nt
    buffer_load_dwordx4 v[36:39], v2, s[8:11], s80 offen offset:1792 nt
    ds_read_b32 v7, v3 offset:52
    ds_read_b32 v5, v3 offset:36
    ds_read_b32 v122, v3 offset:8
    s_waitcnt lgkmcnt(0)
    v_readfirstlane_b32 s85, v7
    v_readfirstlane_b32 s83, v5
    s_cmp_lt_u32 s85, 8
    s_cbranch_scc1 L_PE
    s_cmp_eq_u32 s83, 0
    s_cbranch_scc1 L_PE
    v_readfirstlane_b32 s7, v122
    s_nop 0
    s_cmp_eq_u32 s7, 1
    s_cselect_b64 s[92:93], s[58:59], s[100:101]
    buffer_load_dwordx4 v[72:75], v4, s[92:95], s84 offen sc1
    buffer_load_dwordx4 v[80:83], v4, s[92:95], s84 offen offset:512 sc1
    buffer_load_dwordx4 v[40:43], v2, s[8:11], s81 offen offset:0 nt
    buffer_load_dwordx4 v[44:47], v2, s[8:11], s81 offen offset:256 nt
    buffer_load_dwordx4 v[48:51], v2, s[8:11], s81 offen offset:512 nt
    buffer_load_dwordx4 v[52:55], v2, s[8:11], s81 offen offset:768 nt
    buffer_load_dwordx4 v[56:59], v2, s[8:11], s81 offen offset:1024 nt
    buffer_load_dwordx4 v[60:63], v2, s[8:11], s81 offen offset:1280 nt
    buffer_load_dwordx4 v[64:67], v2, s[8:11], s81 offen offset:1536 nt
    buffer_load_dwordx4 v[68:71], v2, s[8:11], s81 offen offset:1792 nt
    v_mov_b32 v7, 1
    s_mov_b64 exec, 1
    ds_add_u32 v3, v7 offset:52
    s_mov_b64 exec, -1
    s_waitcnt vmcnt(8)
    v_max3_u32 v7, v72, v73, v74
    v_max3_u32 v7, v7, v75, v80
    v_max3_u32 v7, v7, v81, v82
    v_max_u32 v7, v7, v83
    v_cmp_eq_u32 vcc, -1, v7
    s_cbranch_vccnz L_PF
    s_mov_b32 vcc_lo, 0xff00ff00
    s_mov_b32 vcc_hi, 0xff00ff00
    v_cndmask_b32 v76, 0, v72, vcc
    v_cndmask_b32 v77, 0, v73, vcc
    v_cndmask_b32 v78, 0, v74, vcc
    v_cndmask_b32 v79, 0, v75, vcc
    v_cndmask_b32 v84, 0, v80, vcc
    v_cndmask_b32 v85, 0, v81, vcc
    v_cndmask_b32 v86, 0, v82, vcc
    v_cndmask_b32 v87, 0, v83, vcc
    s_not_b64 vcc, vcc
    v_cndmask_b32 v72, 0, v72, vcc
    v_cndmask_b32 v73, 0, v73, vcc
    v_cndmask_b32 v74, 0, v74, vcc
    v_cndmask_b32 v75, 0, v75, vcc
    v_cndmask_b32 v80, 0, v80, vcc
    v_cndmask_b32 v81, 0, v81, vcc
    v_cndmask_b32 v82, 0, v82, vcc
    v_cndmask_b32 v83, 0, v83, vcc
    v_perm_b32 v88, v12, v8, s88
    v_perm_b32 v89, v20, v16, s88
    v_perm_b32 v90, v28, v24, s88
    v_perm_b32 v91, v36, v32, s88
    v_perm_b32 v92, v12, v8, s89
    v_perm_b32 v93, v20, v16, s89
    v_perm_b32 v94, v28, v24, s89
    v_perm_b32 v95, v36, v32, s89
    v_mfma_f32_16x16x32_bf16 v[104:107], v[72:75], v[88:91], 0
    s_nop 0
    v_mfma_f32_16x16x32_bf16 v[104:107], v[76:79], v[92:95], v[104:107]
    v_perm_b32 v96, v13, v9, s88
    v_perm_b32 v97, v21, v17, s88
    v_perm_b32 v98, v29, v25, s88
    v_perm_b32 v99, v37, v33, s88
    v_perm_b32 v100, v13, v9, s89
    v_perm_b32 v101, v21, v17, s89
    v_perm_b32 v102, v29, v25, s89
    v_perm_b32 v103, v37, v33, s89
    v_mfma_f32_16x16x32_bf16 v[108:111], v[72:75], v[96:99], 0
    s_nop 0
    v_mfma_f32_16x16x32_bf16 v[108:111], v[76:79], v[100:103], v[108:111]
    v_perm_b32 v88, v14, v10, s88
    v_perm_b32 v89, v22, v18, s88
    v_perm_b32 v90, v30, v26, s88
    v_perm_b32 v91, v38, v34, s88
    v_perm_b32 v92, v14, v10, s89
    v_perm_b32 v93, v22, v18, s89
    v_perm_b32 v94, v30, v26, s89
    v_perm_b32 v95, v38, v34, s89
    v_mfma_f32_16x16x32_bf16 v[112:115], v[72:75], v[88:91], 0
    s_nop 0
    v_mfma_f32_16x16x32_bf16 v[112:115], v[76:79], v[92:95], v[112:115]
    v_perm_b32 v96, v15, v11, s88
    v_perm_b32 v97, v23, v19, s88
    v_perm_b32 v98, v31, v27, s88
    v_perm_b32 v99, v39, v35, s88
    v_perm_b32 v100, v15, v11, s89
    v_perm_b32 v101, v23, v19, s89
    v_perm_b32 v102, v31, v27, s89
    v_perm_b32 v103, v39, v35, s89
    v_mfma_f32_16x16x32_bf16 v[116:119], v[72:75], v[96:99], 0
    s_nop 0
    v_mfma_f32_16x16x32_bf16 v[116:119], v[76:79], v[100:103], v[116:119]
    s_waitcnt vmcnt(0)
    v_perm_b32 v88, v44, v40, s88
    v_perm_b32 v89, v52, v48, s88
    v_perm_b32 v90, v60, v56, s88
    v_perm_b32 v91, v68, v64, s88
    v_perm_b32 v92, v44, v40, s89
    v_perm_b32 v93, v52, v48, s89
    v_perm_b32 v94, v60, v56, s89
    v_perm_b32 v95, v68, v64, s89
    v_mfma_f32_16x16x32_bf16 v[104:107], v[80:83], v[88:91], v[104:107]
    s_nop 0
    v_mfma_f32_16x16x32_bf16 v[104:107], v[84:87], v[92:95], v[104:107]
    v_perm_b32 v96, v45, v41, s88
    v_perm_b32 v97, v53, v49, s88
    v_perm_b32 v98, v61, v57, s88
    v_perm_b32 v99, v69, v65, s88
    v_perm_b32 v100, v45, v41, s89
    v_perm_b32 v101, v53, v49, s89
    v_perm_b32 v102, v61, v57, s89
    v_perm_b32 v103, v69, v65, s89
    v_mfma_f32_16x16x32_bf16 v[108:111], v[80:83], v[96:99], v[108:111]
    s_nop 0
    v_mfma_f32_16x16x32_bf16 v[108:111], v[84:87], v[100:103], v[108:111]
    v_perm_b32 v88, v46, v42, s88
    v_perm_b32 v89, v54, v50, s88
    v_perm_b32 v90, v62, v58, s88
    v_perm_b32 v91, v70, v66, s88
    v_perm_b32 v92, v46, v42, s89
    v_perm_b32 v93, v54, v50, s89
    v_perm_b32 v94, v62, v58, s89
    v_perm_b32 v95, v70, v66, s89
    v_mfma_f32_16x16x32_bf16 v[112:115], v[80:83], v[88:91], v[112:115]
    s_nop 0
    v_mfma_f32_16x16x32_bf16 v[112:115], v[84:87], v[92:95], v[112:115]
    v_perm_b32 v96, v47, v43, s88
    v_perm_b32 v97, v55, v51, s88
    v_perm_b32 v98, v63, v59, s88
    v_perm_b32 v99, v71, v67, s88
    v_perm_b32 v100, v47, v43, s89
    v_perm_b32 v101, v55, v51, s89
    v_perm_b32 v102, v63, v59, s89
    v_perm_b32 v103, v71, v67, s89
    v_mfma_f32_16x16x32_bf16 v[116:119], v[80:83], v[96:99], v[116:119]
    s_nop 0
    v_mfma_f32_16x16x32_bf16 v[116:119], v[84:87], v[100:103], v[116:119]
    s_mov_b32 exec_lo, 0xff0000ff
    s_mov_b32 exec_hi, 0xff0000ff
    ds_write_b128 v6, v[104:107] offset:0
    ds_write_b128 v6, v[108:111] offset:512
    ds_write_b128 v6, v[112:115] offset:1024
    s_nop 2
    ds_write_b128 v6, v[116:119] offset:1536
    s_mov_b64 exec, -1
    s_branch L_PVD
L_PF:
    buffer_load_dwordx4 v[72:75], v4, s[92:95], s84 offen sc1
    buffer_load_dwordx4 v[80:83], v4, s[92:95], s84 offen offset:512 sc1
    v_perm_b32 v88, v12, v8, s88
    v_perm_b32 v89, v20, v16, s88
    v_perm_b32 v90, v28, v24, s88
    v_perm_b32 v91, v36, v32, s88
    v_perm_b32 v92, v12, v8, s89
    v_perm_b32 v93, v20, v16, s89
    v_perm_b32 v94, v28, v24, s89
    v_perm_b32 v95, v36, v32, s89
    v_perm_b32 v96, v13, v9, s88
    v_perm_b32 v97, v21, v17, s88
    v_perm_b32 v98, v29, v25, s88
    v_perm_b32 v99, v37, v33, s88
    v_perm_b32 v100, v13, v9, s89
    v_perm_b32 v101, v21, v17, s89
    v_perm_b32 v102, v29, v25, s89
    v_perm_b32 v103, v37, v33, s89
    v_perm_b32 v104, v14, v10, s88
    v_perm_b32 v105, v22, v18, s88
    v_perm_b32 v106, v30, v26, s88
    v_perm_b32 v107, v38, v34, s88
    v_perm_b32 v108, v14, v10, s89
    v_perm_b32 v109, v22, v18, s89
    v_perm_b32 v110, v30, v26, s89
    v_perm_b32 v111, v38, v34, s89
    v_perm_b32 v112, v15, v11, s88
    v_perm_b32 v113, v23, v19, s88
    v_perm_b32 v114, v31, v27, s88
    v_perm_b32 v115, v39, v35, s88
    v_perm_b32 v116, v15, v11, s89
    v_perm_b32 v117, v23, v19, s89
    v_perm_b32 v118, v31, v27, s89
    v_perm_b32 v119, v39, v35, s89
    s_waitcnt vmcnt(2)
    v_perm_b32 v8, v44, v40, s88
    v_perm_b32 v9, v52, v48, s88
    v_perm_b32 v10, v60, v56, s88
    v_perm_b32 v11, v68, v64, s88
    v_perm_b32 v12, v44, v40, s89
    v_perm_b32 v13, v52, v48, s89
    v_perm_b32 v14, v60, v56, s89
    v_perm_b32 v15, v68, v64, s89
    v_perm_b32 v16, v45, v41, s88
    v_perm_b32 v17, v53, v49, s88
    v_perm_b32 v18, v61, v57, s88
    v_perm_b32 v19, v69, v65, s88
    v_perm_b32 v20, v45, v41, s89
    v_perm_b32 v21, v53, v49, s89
    v_perm_b32 v22, v61, v57, s89
    v_perm_b32 v23, v69, v65, s89
    v_perm_b32 v24, v46, v42, s88
    v_perm_b32 v25, v54, v50, s88
    v_perm_b32 v26, v62, v58, s88
    v_perm_b32 v27, v70, v66, s88
    v_perm_b32 v28, v46, v42, s89
    v_perm_b32 v29, v54, v50, s89
    v_perm_b32 v30, v62, v58, s89
    v_perm_b32 v31, v70, v66, s89
    v_perm_b32 v32, v47, v43, s88
    v_perm_b32 v33, v55, v51, s88
    v_perm_b32 v34, v63, v59, s88
    v_perm_b32 v35, v71, v67, s88
    v_perm_b32 v36, v47, v43, s89
    v_perm_b32 v37, v55, v51, s89
    v_perm_b32 v38, v63, v59, s89
    v_perm_b32 v39, v71, v67, s89
    s_waitcnt vmcnt(0)
    v_max3_u32 v7, v72, v73, v74
    v_max3_u32 v7, v7, v75, v80
    v_max3_u32 v7, v7, v81, v82
    v_max_u32 v7, v7, v83
    v_cmp_eq_u32 vcc, -1, v7
    s_cbranch_vccz L_PD
    s_branch L_PP
L_PE:
    buffer_load_dwordx4 v[40:43], v2, s[8:11], s81 offen offset:0 nt
    buffer_load_dwordx4 v[44:47], v2, s[8:11], s81 offen offset:256 nt
    buffer_load_dwordx4 v[48:51], v2, s[8:11], s81 offen offset:512 nt
    buffer_load_dwordx4 v[52:55], v2, s[8:11], s81 offen offset:768 nt
    buffer_load_dwordx4 v[56:59], v2, s[8:11], s81 offen offset:1024 nt
    buffer_load_dwordx4 v[60:63], v2, s[8:11], s81 offen offset:1280 nt
    buffer_load_dwordx4 v[64:67], v2, s[8:11], s81 offen offset:1536 nt
    buffer_load_dwordx4 v[68:71], v2, s[8:11], s81 offen offset:1792 nt
    v_mov_b32 v7, 1
    s_mov_b64 exec, 1
    ds_add_u32 v3, v7 offset:52
    s_mov_b64 exec, -1
    s_waitcnt vmcnt(8)
    v_perm_b32 v88, v12, v8, s88
    v_perm_b32 v89, v20, v16, s88
    v_perm_b32 v90, v28, v24, s88
    v_perm_b32 v91, v36, v32, s88
    v_perm_b32 v92, v12, v8, s89
    v_perm_b32 v93, v20, v16, s89
    v_perm_b32 v94, v28, v24, s89
    v_perm_b32 v95, v36, v32, s89
    v_perm_b32 v96, v13, v9, s88
    v_perm_b32 v97, v21, v17, s88
    v_perm_b32 v98, v29, v25, s88
    v_perm_b32 v99, v37, v33, s88
    v_perm_b32 v100, v13, v9, s89
    v_perm_b32 v101, v21, v17, s89
    v_perm_b32 v102, v29, v25, s89
    v_perm_b32 v103, v37, v33, s89
    v_perm_b32 v104, v14, v10, s88
    v_perm_b32 v105, v22, v18, s88
    v_perm_b32 v106, v30, v26, s88
    v_perm_b32 v107, v38, v34, s88
    v_perm_b32 v108, v14, v10, s89
    v_perm_b32 v109, v22, v18, s89
    v_perm_b32 v110, v30, v26, s89
    v_perm_b32 v111, v38, v34, s89
    v_perm_b32 v112, v15, v11, s88
    v_perm_b32 v113, v23, v19, s88
    v_perm_b32 v114, v31, v27, s88
    v_perm_b32 v115, v39, v35, s88
    v_perm_b32 v116, v15, v11, s89
    v_perm_b32 v117, v23, v19, s89
    v_perm_b32 v118, v31, v27, s89
    v_perm_b32 v119, v39, v35, s89
    s_waitcnt vmcnt(0)
    v_perm_b32 v8, v44, v40, s88
    v_perm_b32 v9, v52, v48, s88
    v_perm_b32 v10, v60, v56, s88
    v_perm_b32 v11, v68, v64, s88
    v_perm_b32 v12, v44, v40, s89
    v_perm_b32 v13, v52, v48, s89
    v_perm_b32 v14, v60, v56, s89
    v_perm_b32 v15, v68, v64, s89
    v_perm_b32 v16, v45, v41, s88
    v_perm_b32 v17, v53, v49, s88
    v_perm_b32 v18, v61, v57, s88
    v_perm_b32 v19, v69, v65, s88
    v_perm_b32 v20, v45, v41, s89
    v_perm_b32 v21, v53, v49, s89
    v_perm_b32 v22, v61, v57, s89
    v_perm_b32 v23, v69, v65, s89
    v_perm_b32 v24, v46, v42, s88
    v_perm_b32 v25, v54, v50, s88
    v_perm_b32 v26, v62, v58, s88
    v_perm_b32 v27, v70, v66, s88
    v_perm_b32 v28, v46, v42, s89
    v_perm_b32 v29, v54, v50, s89
    v_perm_b32 v30, v62, v58, s89
    v_perm_b32 v31, v70, v66, s89
    v_perm_b32 v32, v47, v43, s88
    v_perm_b32 v33, v55, v51, s88
    v_perm_b32 v34, v63, v59, s88
    v_perm_b32 v35, v71, v67, s88
    v_perm_b32 v36, v47, v43, s89
    v_perm_b32 v37, v55, v51, s89
    v_perm_b32 v38, v63, v59, s89
    v_perm_b32 v39, v71, v67, s89
SPIN_57:
    ds_read_b32 v7, v3 offset:36
    s_waitcnt lgkmcnt(0)
    v_readfirstlane_b32 s76, v7
    s_nop 0
    s_cmp_ge_u32 s76, 1
    s_cbranch_scc1 SPD_58
    s_cmp_eq_u32 s72, 0
    s_cbranch_scc1 SPD_58
    s_sub_u32 s72, s72, 1
    s_sleep 1
    s_branch SPIN_57
SPD_58:
    ds_read_b32 v7, v3 offset:8
    s_waitcnt lgkmcnt(0)
    v_readfirstlane_b32 s7, v7
    s_nop 0
    s_cmp_eq_u32 s7, 1
    s_cselect_b64 s[92:93], s[58:59], s[100:101]
SPIN_59:
    ds_read_b32 v7, v3 offset:52
    s_waitcnt lgkmcnt(0)
    v_readfirstlane_b32 s76, v7
    s_nop 0
    s_cmp_ge_u32 s76, 12
    s_cbranch_scc1 SPD_60
    s_cmp_eq_u32 s72, 0
    s_cbranch_scc1 SPD_60
    s_sub_u32 s72, s72, 1
    s_sleep 2
    s_branch SPIN_59
SPD_60:
L_PP:
POLL_61:
    buffer_load_dwordx4 v[72:75], v4, s[92:95], s84 offen sc1
    buffer_load_dwordx4 v[80:83], v4, s[92:95], s84 offen offset:512 sc1
    s_waitcnt vmcnt(0)
    v_max3_u32 v7, v72, v73, v74
    v_max3_u32 v7, v7, v75, v80
    v_max3_u32 v7, v7, v81, v82
    v_max_u32 v7, v7, v83
    v_cmp_eq_u32 vcc, -1, v7
    s_cbranch_vccz PLD_62
    s_cmp_eq_u32 s72, 0
    s_cbranch_scc1 PLD_62
    s_sub_u32 s72, s72, 1
    s_sleep 4
    s_branch POLL_61
PLD_62:
L_PD:
    s_mov_b32 vcc_lo, 0xff00ff00
    s_mov_b32 vcc_hi, 0xff00ff00
    v_cndmask_b32 v76, 0, v72, vcc
    v_cndmask_b32 v77, 0, v73, vcc
    v_cndmask_b32 v78, 0, v74, vcc
    v_cndmask_b32 v79, 0, v75, vcc
    v_cndmask_b32 v84, 0, v80, vcc
    v_cndmask_b32 v85, 0, v81, vcc
    v_cndmask_b32 v86, 0, v82, vcc
    v_cndmask_b32 v87, 0, v83, vcc
    s_not_b64 vcc, vcc
    v_cndmask_b32 v72, 0, v72, vcc
    v_cndmask_b32 v73, 0, v73, vcc
    v_cndmask_b32 v74, 0, v74, vcc
    v_cndmask_b32 v75, 0, v75, vcc
    v_cndmask_b32 v80, 0, v80, vcc
    v_cndmask_b32 v81, 0, v81, vcc
    v_cndmask_b32 v82, 0, v82, vcc
    v_cndmask_b32 v83, 0, v83, vcc
    v_mfma_f32_16x16x32_bf16 v[40:43], v[72:75], v[88:91], 0
    v_mfma_f32_16x16x32_bf16 v[44:47], v[72:75], v[96:99], 0
    v_mfma_f32_16x16x32_bf16 v[48:51], v[72:75], v[104:107], 0
    v_mfma_f32_16x16x32_bf16 v[52:55], v[72:75], v[112:115], 0
    v_mfma_f32_16x16x32_bf16 v[40:43], v[76:79], v[92:95], v[40:43]
    v_mfma_f32_16x16x32_bf16 v[44:47], v[76:79], v[100:103], v[44:47]
    v_mfma_f32_16x16x32_bf16 v[48:51], v[76:79], v[108:111], v[48:51]
    v_mfma_f32_16x16x32_bf16 v[52:55], v[76:79], v[116:119], v[52:55]
    v_mfma_f32_16x16x32_bf16 v[40:43], v[80:83], v[8:11], v[40:43]
    v_mfma_f32_16x16x32_bf16 v[44:47], v[80:83], v[16:19], v[44:47]
    v_mfma_f32_16x16x32_bf16 v[48:51], v[80:83], v[24:27], v[48:51]
    v_mfma_f32_16x16x32_bf16 v[52:55], v[80:83], v[32:35], v[52:55]
    v_mfma_f32_16x16x32_bf16 v[40:43], v[84:87], v[12:15], v[40:43]
    v_mfma_f32_16x16x32_bf16 v[44:47], v[84:87], v[20:23], v[44:47]
    v_mfma_f32_16x16x32_bf16 v[48:51], v[84:87], v[28:31], v[48:51]
    v_mfma_f32_16x16x32_bf16 v[52:55], v[84:87], v[36:39], v[52:55]
    s_mov_b32 exec_lo, 0xff0000ff
    s_mov_b32 exec_hi, 0xff0000ff
    s_nop 2
    ds_write_b128 v6, v[40:43] offset:0
    ds_write_b128 v6, v[44:47] offset:512
    ds_write_b128 v6, v[48:51] offset:1024
    ds_write_b128 v6, v[52:55] offset:1536
    s_mov_b64 exec, -1
L_PVD:
    s_waitcnt lgkmcnt(0)
    s_barrier
    s_cmp_lt_u32 s3, 8
    s_cbranch_scc1 L_VT
    ds_read_b128 v[8:11], v120 offset:0
    ds_read_b128 v[12:15], v120 offset:128
    ds_read_b128 v[16:19], v120 offset:2112
    ds_read_b128 v[20:23], v120 offset:2240
    s_waitcnt lgkmcnt(0)
    v_add_f32 v8, v8, v12
    v_add_f32 v16, v16, v20
    v_add_f32 v9, v9, v13
    v_add_f32 v17, v17, v21
    v_add_f32 v10, v10, v14
    v_add_f32 v18, v18, v22
    v_add_f32 v11, v11, v15
    v_add_f32 v19, v19, v23
    v_add_f32 v8, v8, v16
    v_add_f32 v9, v9, v17
    v_add_f32 v10, v10, v18
    v_add_f32 v11, v11, v19
    v_add_f32_dpp v8, v8, v8 row_ror:8 row_mask:0xf bank_mask:0xf
    v_add_f32_dpp v9, v9, v9 row_ror:8 row_mask:0xf bank_mask:0xf
    v_add_f32_dpp v10, v10, v10 row_ror:8 row_mask:0xf bank_mask:0xf
    v_add_f32_dpp v11, v11, v11 row_ror:8 row_mask:0xf bank_mask:0xf
    v_mov_b32 v12, v8
    v_mov_b32 v13, v9
    v_mov_b32 v14, v10
    v_mov_b32 v15, v11
    v_permlane16_swap_b32 v8, v12
    v_permlane16_swap_b32 v9, v13
    v_permlane16_swap_b32 v10, v14
    v_permlane16_swap_b32 v11, v15
    v_add_f32 v8, v8, v12
    v_add_f32 v9, v9, v13
    v_add_f32 v10, v10, v14
    v_add_f32 v11, v11, v15
    v_mov_b32 v12, v8
    v_mov_b32 v13, v9
    v_mov_b32 v14, v10
    v_mov_b32 v15, v11
    v_permlane32_swap_b32 v8, v12
    v_permlane32_swap_b32 v9, v13
    v_permlane32_swap_b32 v10, v14
    v_permlane32_swap_b32 v11, v15
    v_add_f32 v8, v8, v12
    v_add_f32 v9, v9, v13
    v_add_f32 v10, v10, v14
    v_add_f32 v11, v11, v15
    v_cvt_pk_bf16_f32 v12, v8, v9
    v_cvt_pk_bf16_f32 v13, v10, v11
    v_min_u32 v12, -2, v12
    v_min_u32 v13, -2, v13
    s_mov_b64 exec, 0xff
    s_cmp_eq_u32 s7, 1
    s_cbranch_scc1 PUBL_63
    buffer_store_dwordx2 v[12:13], v121, s[92:95], s86 offen sc1
    s_branch PUBD_64
PUBL_63:
    buffer_store_dwordx2 v[12:13], v121, s[92:95], s86 offen
PUBD_64:
    s_mov_b64 exec, -1
    s_branch L_END
L_VT:
    s_cmp_lg_u32 s6, 0
    s_cbranch_scc1 L_END
    ds_read_b32 v13, v3 offset:12
    v_lshrrev_b32 v5, 4, v1
    v_lshlrev_b32 v4, 9, v5
    v_and_b32 v5, 15, v1
    v_lshl_add_u32 v4, v5, 2, v4
    s_lshl_b32 s80, s3, 6
    v_add_u32 v4, s80, v4
    v_lshrrev_b32 v5, 1, v1
    v_lshlrev_b32 v5, 2, v5
    v_lshlrev_b32 v7, 1, v1
    s_lshl_b32 s81, s5, 7
    s_lshl_b32 s82, s3, 10
    s_add_u32 s82, s82, s81
    s_lshl_b32 s80, s3, 12
    s_add_u32 s80, s80, s81
    s_add_u32 s80, s80, 4194304
    s_add_u32 s81, s80, 131072
    buffer_load_ushort v56, v7, s[60:63], s82 offen
    s_waitcnt lgkmcnt(0)
XP_65:
    buffer_load_dword v50, v5, s[16:19], s80 offen sc1
    buffer_load_dword v51, v5, s[16:19], s80 offen offset:3072 sc1
    buffer_load_dword v52, v5, s[16:19], s81 offen sc1
    buffer_load_dword v53, v5, s[16:19], s81 offen offset:3072 sc1
    s_waitcnt vmcnt(0)
    v_xor_b32 v52, v52, v50
    v_xor_b32 v53, v53, v51
    v_xor_b32 v12, v52, v13
    v_bitop3_b32 v12, v12, v53, v13 bitop3:0xf6
    v_cmp_ne_u32 vcc, 0, v12
    s_cbranch_vccz XPD_66
    s_cmp_eq_u32 s72, 0
    s_cbranch_scc1 XPD_66
    s_sub_u32 s72, s72, 1
    s_branch XP_65
XPD_66:
    v_lshlrev_b32 v46, 16, v50
    v_and_b32 v47, 0xffff0000, v50
    v_lshlrev_b32 v48, 16, v51
    v_and_b32 v49, 0xffff0000, v51
    s_mov_b32 vcc_lo, 0xaaaaaaaa
    s_mov_b32 vcc_hi, 0xaaaaaaaa
    v_cndmask_b32 v46, v46, v47, vcc
    v_cndmask_b32 v48, v48, v49, vcc
    v_lshlrev_b32 v56, 16, v56
    s_lshl_b32 s83, s73, 10
    s_lshl_b32 s84, s3, 7
    s_add_u32 s83, s83, s84
    s_add_u32 s83, s83, 1179648
    s_lshl_b32 s80, s5, 14
    s_add_u32 s85, s80, 4587520
    s_add_u32 s80, s80, 4456448
    s_add_u32 s88, s80, 0
    s_add_u32 s89, s80, 4096
    s_add_u32 s90, s80, 8192
    s_add_u32 s91, s80, 12288
POLL_67:
    buffer_load_dword v16, v4, s[16:19], s88 offen offset:0 sc1
    buffer_load_dword v17, v4, s[16:19], s88 offen offset:2048 sc1
    buffer_load_dword v18, v4, s[16:19], s89 offen offset:0 sc1
    buffer_load_dword v19, v4, s[16:19], s89 offen offset:2048 sc1
    buffer_load_dword v20, v4, s[16:19], s90 offen offset:0 sc1
    buffer_load_dword v21, v4, s[16:19], s90 offen offset:2048 sc1
    buffer_load_dword v22, v4, s[16:19], s91 offen offset:0 sc1
    buffer_load_dword v23, v4, s[16:19], s91 offen offset:2048 sc1
    s_waitcnt vmcnt(0)
    v_max3_u32 v12, v16, v17, v18
    v_max3_u32 v12, v12, v19, v20
    v_max3_u32 v12, v12, v21, v22
    v_max_u32 v12, v12, v23
    v_cmp_eq_u32 vcc, -1, v12
    s_cbranch_vccz PLD_68
    s_cmp_eq_u32 s72, 0
    s_cbranch_scc1 PLD_68
    s_sub_u32 s72, s72, 1
    s_branch POLL_67
PLD_68:
    v_add_f32 v16, v16, v17
    v_add_f32 v18, v18, v19
    v_add_f32 v20, v20, v21
    v_add_f32 v22, v22, v23
    v_add_f32 v16, v16, v18
    v_add_f32 v20, v20, v22
    v_add_f32 v16, v16, v20
    v_cvt_pk_bf16_f32 v12, v16, v16
    v_lshlrev_b32 v16, 16, v12
    v_mul_f32 v16, v16, v46
    v_cvt_pk_bf16_f32 v12, v16, v16
    v_lshlrev_b32 v16, 16, v12
    v_add_f32 v16, v16, v56
    v_cvt_pk_bf16_f32 v12, v16, v16
    v_min_u32 v12, -2, v12
    s_cmp_eq_u32 s7, 1
    s_cbranch_scc1 PUBL_69
    buffer_store_short v12, v7, s[92:95], s83 offen sc1
    s_branch PUBD_70
PUBL_69:
    buffer_store_short v12, v7, s[92:95], s83 offen
PUBD_70:
    s_cmp_lg_u32 s3, s4
    s_cbranch_scc1 L_END
    v_lshlrev_b32 v50, 16, v12
    s_add_u32 s88, s85, 0
    s_add_u32 s89, s85, 4096
    s_add_u32 s90, s85, 8192
    s_add_u32 s91, s85, 12288
POLL_71:
    buffer_load_dword v16, v4, s[16:19], s88 offen offset:0 sc1
    buffer_load_dword v17, v4, s[16:19], s88 offen offset:2048 sc1
    buffer_load_dword v18, v4, s[16:19], s89 offen offset:0 sc1
    buffer_load_dword v19, v4, s[16:19], s89 offen offset:2048 sc1
    buffer_load_dword v20, v4, s[16:19], s90 offen offset:0 sc1
    buffer_load_dword v21, v4, s[16:19], s90 offen offset:2048 sc1
    buffer_load_dword v22, v4, s[16:19], s91 offen offset:0 sc1
    s_waitcnt vmcnt(0)
    v_max3_u32 v12, v16, v17, v18
    v_max3_u32 v12, v12, v19, v20
    v_max3_u32 v12, v12, v21, v22
    v_cmp_eq_u32 vcc, -1, v12
    s_cbranch_vccz PLD_72
    s_cmp_eq_u32 s72, 0
    s_cbranch_scc1 PLD_72
    s_sub_u32 s72, s72, 1
    s_branch POLL_71
PLD_72:
    v_add_f32 v16, v16, v17
    v_add_f32 v18, v18, v19
    v_add_f32 v20, v20, v21
    v_add_f32 v16, v16, v18
    v_add_f32 v20, v20, v22
    v_add_f32 v16, v16, v20
    v_cvt_pk_bf16_f32 v12, v16, v16
    v_lshlrev_b32 v16, 16, v12
    v_mul_f32 v16, v16, v48
    v_cvt_pk_bf16_f32 v12, v16, v16
    v_lshlrev_b32 v16, 16, v12
    v_add_f32 v16, v16, v50
    v_cvt_pk_bf16_f32 v12, v16, v16
    buffer_store_short v12, v7, s[64:67], s82 offen
    s_branch L_DUMP
L_KPATH:
    v_lshlrev_b32 v4, 4, v1
    s_and_b32 s86, s6, 1
    s_lshl_b32 s80, s86, 18
    s_lshr_b32 s81, s3, 3
    s_lshl_b32 s81, s81, 5
    s_and_b32 s82, s3, 7
    s_add_u32 s81, s81, s82
    s_lshl_b32 s81, s81, 12
    s_add_u32 s80, s80, s81
    s_cmp_ge_u32 s3, 8
    s_cbranch_scc1 L_KA
    s_add_u32 s80, s80, 0
    s_branch L_KB
L_KA:
    buffer_load_dwordx4 v[16:19], v4, s[8:11], s80 offen offset:0 nt
    buffer_load_dwordx4 v[20:23], v4, s[8:11], s80 offen offset:1024 nt
    buffer_load_dwordx4 v[24:27], v4, s[8:11], s80 offen offset:2048 nt
    buffer_load_dwordx4 v[28:31], v4, s[8:11], s80 offen offset:3072 nt
L_KB:
    s_add_u32 s80, s80, 32768
    buffer_load_dwordx4 v[32:35], v4, s[8:11], s80 offen offset:0 nt
    buffer_load_dwordx4 v[36:39], v4, s[8:11], s80 offen offset:1024 nt
    buffer_load_dwordx4 v[40:43], v4, s[8:11], s80 offen offset:2048 nt
    buffer_load_dwordx4 v[44:47], v4, s[8:11], s80 offen offset:3072 nt
    s_add_u32 s80, s80, 32768
    buffer_load_dwordx4 v[48:51], v4, s[8:11], s80 offen offset:0 nt
    buffer_load_dwordx4 v[52:55], v4, s[8:11], s80 offen offset:1024 nt
    buffer_load_dwordx4 v[56:59], v4, s[8:11], s80 offen offset:2048 nt
    buffer_load_dwordx4 v[60:63], v4, s[8:11], s80 offen offset:3072 nt
    s_add_u32 s80, s80, 32768
    s_cmp_lt_u32 s3, 8
    s_cbranch_scc1 L_K3L
    v_and_b32 v5, 15, v1
    v_lshlrev_b32 v6, 8, v5
    v_lshrrev_b32 v5, 4, v1
    v_lshl_add_u32 v6, v5, 4, v6
    buffer_load_dwordx4 v[64:67], v6, s[8:11], s80 offen offset:0 nt
    buffer_load_dwordx4 v[68:71], v6, s[8:11], s80 offen offset:64 nt
    buffer_load_dwordx4 v[72:75], v6, s[8:11], s80 offen offset:128 nt
    buffer_load_dwordx4 v[76:79], v6, s[8:11], s80 offen offset:192 nt
    s_branch L_K3D
L_K3L:
    buffer_load_dwordx4 v[64:67], v4, s[8:11], s80 offen offset:0 nt
    buffer_load_dwordx4 v[68:71], v4, s[8:11], s80 offen offset:1024 nt
    buffer_load_dwordx4 v[72:75], v4, s[8:11], s80 offen offset:2048 nt
    buffer_load_dwordx4 v[76:79], v4, s[8:11], s80 offen offset:3072 nt
L_K3D:
    s_mul_i32 s81, s3, 4352
    s_add_u32 s81, s81, 0
    v_lshrrev_b32 v6, 4, v1
    v_and_b32 v7, 15, v1
    v_mul_u32_u24 v4, 272, v6
    v_lshl_add_u32 v4, v7, 4, v4
    v_add_u32 v4, s81, v4
    v_mul_u32_u24 v5, 272, v7
    v_lshl_add_u32 v5, v6, 4, v5
    v_add_u32 v5, s81, v5
    s_waitcnt vmcnt(12)
    ds_write_b128 v4, v[16:19] offset:0
    ds_write_b128 v4, v[20:23] offset:1088
    ds_write_b128 v4, v[24:27] offset:2176
    ds_write_b128 v4, v[28:31] offset:3264
    s_waitcnt lgkmcnt(0)
    ds_read_b128 v[16:19], v5 offset:0
    ds_read_b128 v[20:23], v5 offset:64
    ds_read_b128 v[24:27], v5 offset:128
    ds_read_b128 v[28:31], v5 offset:192
    s_waitcnt lgkmcnt(0)
    s_waitcnt vmcnt(8)
    ds_write_b128 v4, v[32:35] offset:0
    ds_write_b128 v4, v[36:39] offset:1088
    ds_write_b128 v4, v[40:43] offset:2176
    ds_write_b128 v4, v[44:47] offset:3264
    s_waitcnt lgkmcnt(0)
    ds_read_b128 v[32:35], v5 offset:0
    ds_read_b128 v[36:39], v5 offset:64
    ds_read_b128 v[40:43], v5 offset:128
    ds_read_b128 v[44:47], v5 offset:192
    s_waitcnt lgkmcnt(0)
    s_waitcnt vmcnt(4)
    ds_write_b128 v4, v[48:51] offset:0
    ds_write_b128 v4, v[52:55] offset:1088
    ds_write_b128 v4, v[56:59] offset:2176
    ds_write_b128 v4, v[60:63] offset:3264
    s_waitcnt lgkmcnt(0)
    ds_read_b128 v[48:51], v5 offset:0
    ds_read_b128 v[52:55], v5 offset:64
    ds_read_b128 v[56:59], v5 offset:128
    ds_read_b128 v[60:63], v5 offset:192
    s_waitcnt lgkmcnt(0)
    s_cmp_ge_u32 s3, 8
    s_cbranch_scc1 L_KRS
    s_waitcnt vmcnt(0)
    ds_write_b128 v4, v[64:67] offset:0
    ds_write_b128 v4, v[68:71] offset:1088
    ds_write_b128 v4, v[72:75] offset:2176
    ds_write_b128 v4, v[76:79] offset:3264
    s_waitcnt lgkmcnt(0)
    ds_read_b128 v[64:67], v5 offset:0
    ds_read_b128 v[68:71], v5 offset:64
    ds_read_b128 v[72:75], v5 offset:128
    ds_read_b128 v[76:79], v5 offset:192
    s_waitcnt lgkmcnt(0)
L_KRS:
    v_mov_b32 v7, 1
    s_mov_b64 exec, 1
    ds_add_u32 v3, v7 offset:52
    s_mov_b64 exec, -1
    s_setprio 2
    s_cmp_gt_u32 s3, 3
    s_cbranch_scc1 L_QPX
SPIN_73:
    ds_read_b32 v12, v3 offset:12
    s_waitcnt lgkmcnt(0)
    v_readfirstlane_b32 s76, v12
    s_nop 0
    s_cmp_ge_u32 s76, 1
    s_cbranch_scc1 SPD_74
    s_cmp_eq_u32 s72, 0
    s_cbranch_scc1 SPD_74
    s_sub_u32 s72, s72, 1
    s_sleep 1
    s_branch SPIN_73
SPD_74:
    s_cmp_lg_u32 s3, 1
    s_cbranch_scc1 L_QP0
    s_mov_b32 s79, 1
    s_branch L_FLAGS
L_KFLB:
    s_branch L_QPX
L_QP0:
    s_lshl_b32 s80, s4, 13
    s_lshl_b32 s81, s5, 7
    s_add_u32 s80, s80, s81
    s_add_u32 s80, s80, 3145728
    s_add_u32 s81, s80, 65536
    v_lshrrev_b32 v6, 3, v1
    v_lshlrev_b32 v5, 10, v6
    v_and_b32 v7, 7, v1
    v_lshl_add_u32 v5, v7, 4, v5
    v_lshrrev_b32 v6, 4, v1
    v_mul_u32_u24 v13, 272, v6
    v_and_b32 v7, 15, v1
    v_lshl_add_u32 v13, v7, 4, v13
    v_add_u32 v13, 139776, v13
    s_lshr_b32 s84, s3, 1
    s_and_b32 s85, s3, 1
    s_add_u32 s84, s84, s85
    s_mul_i32 s84, s84, 1
    s_add_u32 s84, s84, 8
SPIN_75:
    ds_read_b32 v7, v3 offset:52
    s_waitcnt lgkmcnt(0)
    v_readfirstlane_b32 s76, v7
    s_nop 0
    s_cmp_ge_u32 s76, s84
    s_cbranch_scc1 SPD_76
    s_cmp_eq_u32 s72, 0
    s_cbranch_scc1 SPD_76
    s_sub_u32 s72, s72, 1
    s_sleep 2
    s_branch SPIN_75
SPD_76:
L_QPL:
    ds_read_b32 v7, v3 offset:4
    s_waitcnt lgkmcnt(0)
    v_readfirstlane_b32 s76, v7
    s_nop 0
    s_cmp_lg_u32 s76, 0
    s_cbranch_scc1 L_QPX
    buffer_load_dwordx4 v[96:99], v5, s[16:19], s80 offen sc1
    buffer_load_dwordx4 v[100:103], v5, s[16:19], s81 offen sc1
    s_waitcnt vmcnt(0)
    v_xor_b32 v100, v100, v96
    v_xor_b32 v101, v101, v97
    v_xor_b32 v102, v102, v98
    v_xor_b32 v103, v103, v99
    v_xor_b32 v7, v100, v12
    v_bitop3_b32 v7, v7, v101, v12 bitop3:0xf6
    v_bitop3_b32 v7, v7, v102, v12 bitop3:0xf6
    v_bitop3_b32 v7, v7, v103, v12 bitop3:0xf6
    v_cmp_ne_u32 vcc, 0, v7
    s_cbranch_vccz L_QPD
    s_cmp_eq_u32 s72, 0
    s_cbranch_scc1 L_QPD
    s_sub_u32 s72, s72, 1
    s_sleep 2
    s_branch L_QPL
L_QPD:
    ds_write_b128 v13, v[96:99]
    s_waitcnt lgkmcnt(0)
    v_mov_b32 v7, 1
    ds_write_b32 v3, v7 offset:4
L_QPX:
    v_and_b32 v6, 3, v1
    v_mul_u32_u24 v6, 272, v6
    v_lshrrev_b32 v7, 4, v1
    v_lshl_add_u32 v6, v7, 4, v6
    v_add_u32 v6, 139776, v6
    v_bfe_u32 v5, v1, 2, 2
    v_lshlrev_b32 v4, 10, v5
    v_lshrrev_b32 v5, 5, v1
    v_lshl_add_u32 v4, v5, 6, v4
    v_and_b32 v5, 3, v1
    v_lshl_add_u32 v4, v5, 4, v4
    v_bfe_u32 v5, v1, 4, 1
    v_lshl_add_u32 v4, v5, 3, v4
    s_and_b32 s86, s6, 1
    s_lshl_b32 s81, s73, 14
    s_lshl_b32 s82, s86, 13
    s_add_u32 s81, s81, s82
    s_lshr_b32 s82, s3, 3
    s_lshl_b32 s82, s82, 5
    s_and_b32 s83, s3, 7
    s_add_u32 s82, s82, s83
    s_lshl_b32 s82, s82, 7
    s_add_u32 s81, s81, s82
    v_lshlrev_b32 v5, 4, v1
    s_lshl_b32 s82, s73, 10
    s_add_u32 s82, s82, 1114112
    s_lshl_b32 s83, s86, 9
    s_add_u32 s83, s82, s83
    s_lshr_b32 s84, s3, 1
    s_lshl_b32 s84, s84, 6
    s_add_u32 s83, s83, s84
    s_and_b32 s84, s3, 1
    s_lshl_b32 s84, s84, 3
    s_add_u32 s83, s83, s84
    v_and_b32 v15, 3, v1
    v_lshl_add_u32 v15, v15, 3, v3
SPIN_77:
    ds_read_b32 v7, v3 offset:36
    s_waitcnt lgkmcnt(0)
    v_readfirstlane_b32 s76, v7
    s_nop 0
    s_cmp_ge_u32 s76, 1
    s_cbranch_scc1 SPD_78
    s_cmp_eq_u32 s72, 0
    s_cbranch_scc1 SPD_78
    s_sub_u32 s72, s72, 1
    s_sleep 1
    s_branch SPIN_77
SPD_78:
    ds_read_b32 v7, v3 offset:8
    s_waitcnt lgkmcnt(0)
    v_readfirstlane_b32 s7, v7
    s_nop 0
    s_cmp_eq_u32 s7, 1
    s_cselect_b64 s[92:93], s[58:59], s[100:101]
SPIN_79:
    ds_read_b32 v7, v3 offset:4
    s_waitcnt lgkmcnt(0)
    v_readfirstlane_b32 s76, v7
    s_nop 0
    s_cmp_ge_u32 s76, 1
    s_cbranch_scc1 SPD_80
    s_cmp_eq_u32 s72, 0
    s_cbranch_scc1 SPD_80
    s_sub_u32 s72, s72, 1
    s_sleep 1
    s_branch SPIN_79
SPD_80:
    ds_read_b128 v[96:99], v6 offset:0
    ds_read_b128 v[100:103], v6 offset:64
    ds_read_b128 v[104:107], v6 offset:128
    ds_read_b128 v[108:111], v6 offset:192
    s_waitcnt lgkmcnt(3)
    v_mfma_f32_16x16x32_bf16 v[80:83], v[16:19], v[96:99], 0
    v_mfma_f32_16x16x32_bf16 v[84:87], v[32:35], v[96:99], 0
    v_mfma_f32_16x16x32_bf16 v[88:91], v[48:51], v[96:99], 0
    s_waitcnt lgkmcnt(2)
    v_mfma_f32_16x16x32_bf16 v[80:83], v[20:23], v[100:103], v[80:83]
    v_mfma_f32_16x16x32_bf16 v[84:87], v[36:39], v[100:103], v[84:87]
    v_mfma_f32_16x16x32_bf16 v[88:91], v[52:55], v[100:103], v[88:91]
    s_waitcnt lgkmcnt(1)
    v_mfma_f32_16x16x32_bf16 v[80:83], v[24:27], v[104:107], v[80:83]
    v_mfma_f32_16x16x32_bf16 v[84:87], v[40:43], v[104:107], v[84:87]
    v_mfma_f32_16x16x32_bf16 v[88:91], v[56:59], v[104:107], v[88:91]
    s_waitcnt lgkmcnt(0)
    v_mfma_f32_16x16x32_bf16 v[80:83], v[28:31], v[108:111], v[80:83]
    v_mfma_f32_16x16x32_bf16 v[84:87], v[44:47], v[108:111], v[84:87]
    v_mfma_f32_16x16x32_bf16 v[88:91], v[60:63], v[108:111], v[88:91]
    s_waitcnt vmcnt(3)
    v_mfma_f32_16x16x32_bf16 v[92:95], v[64:67], v[96:99], 0
    s_waitcnt vmcnt(2)
    v_mfma_f32_16x16x32_bf16 v[92:95], v[68:71], v[100:103], v[92:95]
    s_waitcnt vmcnt(1)
    v_mfma_f32_16x16x32_bf16 v[92:95], v[72:75], v[104:107], v[92:95]
    s_waitcnt vmcnt(0)
    v_mfma_f32_16x16x32_bf16 v[92:95], v[76:79], v[108:111], v[92:95]
    s_mov_b32 vcc_lo, 0xf000f0
    s_mov_b32 vcc_hi, 0xf000f0
    v_cndmask_b32 v80, v80, v84, vcc
    v_cndmask_b32 v81, v81, v85, vcc
    v_cndmask_b32 v82, v82, v86, vcc
    v_cndmask_b32 v83, v83, v87, vcc
    s_mov_b32 vcc_lo, 0xf000f00
    s_mov_b32 vcc_hi, 0xf000f00
    v_cndmask_b32 v80, v80, v88, vcc
    v_cndmask_b32 v81, v81, v89, vcc
    v_cndmask_b32 v82, v82, v90, vcc
    v_cndmask_b32 v83, v83, v91, vcc
    s_mov_b32 vcc_lo, 0xf000f000
    s_mov_b32 vcc_hi, 0xf000f000
    v_cndmask_b32 v80, v80, v92, vcc
    v_cndmask_b32 v81, v81, v93, vcc
    v_cndmask_b32 v82, v82, v94, vcc
    v_cndmask_b32 v83, v83, v95, vcc
    v_cvt_pk_bf16_f32 v8, v80, v81
    v_lshlrev_b32 v80, 16, v8
    v_and_b32 v81, 0xffff0000, v8
    v_cvt_pk_bf16_f32 v9, v82, v83
    v_lshlrev_b32 v82, 16, v9
    v_and_b32 v83, 0xffff0000, v9
    v_mul_f32 v80, 0x3db504f3, v80
    v_mul_f32 v81, 0x3db504f3, v81
    v_mul_f32 v82, 0x3db504f3, v82
    v_mul_f32 v83, 0x3db504f3, v83
    v_cvt_pk_bf16_f32 v8, v80, v81
    v_lshlrev_b32 v80, 16, v8
    v_and_b32 v81, 0xffff0000, v8
    v_cvt_pk_bf16_f32 v9, v82, v83
    v_lshlrev_b32 v82, 16, v9
    v_and_b32 v83, 0xffff0000, v9
    v_max3_f32 v10, v80, v81, v82
    v_max_f32 v10, v10, v83
    s_nop 1
    v_max_f32_dpp v10, v10, v10 row_ror:4 row_mask:0xf bank_mask:0xf
    s_nop 1
    v_max_f32_dpp v10, v10, v10 row_ror:8 row_mask:0xf bank_mask:0xf
    v_mov_b32 v12, v10
    s_nop 1
    v_permlane16_swap_b32 v10, v12
    v_max_f32 v10, v10, v12
    v_mov_b32 v12, v10
    s_nop 1
    v_permlane32_swap_b32 v10, v12
    v_max_f32 v10, v10, v12
    v_sub_f32 v80, v80, v10
    v_sub_f32 v81, v81, v10
    v_sub_f32 v82, v82, v10
    v_sub_f32 v83, v83, v10
    v_mul_f32 v80, 0x3fb8aa3b, v80
    v_mul_f32 v81, 0x3fb8aa3b, v81
    v_mul_f32 v82, 0x3fb8aa3b, v82
    v_mul_f32 v83, 0x3fb8aa3b, v83
    v_exp_f32 v80, v80
    v_exp_f32 v81, v81
    v_exp_f32 v82, v82
    v_exp_f32 v83, v83
    v_add_f32 v11, v80, v81
    v_add_f32 v12, v82, v83
    v_add_f32 v11, v11, v12
    s_nop 1
    v_add_f32_dpp v11, v11, v11 row_ror:4 row_mask:0xf bank_mask:0xf
    s_nop 1
    v_add_f32_dpp v11, v11, v11 row_ror:8 row_mask:0xf bank_mask:0xf
    v_mov_b32 v12, v11
    s_nop 1
    v_permlane16_swap_b32 v11, v12
    v_add_f32 v11, v11, v12
    v_mov_b32 v12, v11
    s_nop 1
    v_permlane32_swap_b32 v11, v12
    v_add_f32 v11, v11, v12
    v_min_u32 v10, -2, v10
    v_min_u32 v11, -2, v11
    s_mov_b64 exec, 15
    s_cmp_eq_u32 s7, 1
    s_cbranch_scc1 PUBL_81
    buffer_store_dwordx2 v[10:11], v5, s[92:95], s83 offen sc1
    s_branch PUBD_82
PUBL_81:
    buffer_store_dwordx2 v[10:11], v5, s[92:95], s83 offen
PUBD_82:
    s_mov_b64 exec, -1
    v_mov_b32 v7, 1
    s_mov_b64 exec, 1
    ds_add_u32 v3, v7 offset:20
    s_mov_b64 exec, -1
    s_cmp_lg_u32 s3, 0
    s_cbranch_scc1 L_STW
SPIN_83:
    ds_read_b32 v7, v3 offset:20
    s_waitcnt lgkmcnt(0)
    v_readfirstlane_b32 s76, v7
    s_nop 0
    s_cmp_ge_u32 s76, 16
    s_cbranch_scc1 SPD_84
    s_cmp_eq_u32 s72, 0
    s_cbranch_scc1 SPD_84
    s_sub_u32 s72, s72, 1
    s_branch SPIN_83
SPD_84:
POLL_85:
    buffer_load_dwordx4 v[24:27], v5, s[92:95], s82 offen sc1
    s_waitcnt vmcnt(0)
    v_max3_u32 v12, v24, v25, v26
    v_max_u32 v12, v12, v27
    v_cmp_eq_u32 vcc, -1, v12
    s_cbranch_vccz PLD_86
    s_cmp_eq_u32 s72, 0
    s_cbranch_scc1 PLD_86
    s_sub_u32 s72, s72, 1
    s_branch POLL_85
PLD_86:
    v_max_f32 v28, v24, v26
    s_nop 1
    v_max_f32_dpp v28, v28, v28 row_ror:4 row_mask:0xf bank_mask:0xf
    s_nop 1
    v_max_f32_dpp v28, v28, v28 row_ror:8 row_mask:0xf bank_mask:0xf
    v_mov_b32 v12, v28
    s_nop 1
    v_permlane16_swap_b32 v28, v12
    v_max_f32 v28, v28, v12
    v_mov_b32 v12, v28
    s_nop 1
    v_permlane32_swap_b32 v28, v12
    v_max_f32 v28, v28, v12
    v_sub_f32 v24, v24, v28
    v_sub_f32 v26, v26, v28
    v_mul_f32 v24, 0x3fb8aa3b, v24
    v_mul_f32 v26, 0x3fb8aa3b, v26
    v_exp_f32 v24, v24
    v_exp_f32 v26, v26
    v_mul_f32 v21, v24, v25
    v_fmac_f32 v21, v26, v27
    s_nop 1
    v_add_f32_dpp v21, v21, v21 row_ror:4 row_mask:0xf bank_mask:0xf
    s_nop 1
    v_add_f32_dpp v21, v21, v21 row_ror:8 row_mask:0xf bank_mask:0xf
    v_mov_b32 v12, v21
    s_nop 1
    v_permlane16_swap_b32 v21, v12
    v_add_f32 v21, v21, v12
    v_mov_b32 v12, v21
    s_nop 1
    v_permlane32_swap_b32 v21, v12
    v_add_f32 v21, v21, v12
    v_rcp_f32 v29, v21
    s_nop 0
    v_fma_f32 v30, -v21, v29, 1.0
    v_fmac_f32 v29, v30, v29
    v_max_u32 v29, 1, v29
    s_mov_b64 exec, 15
    ds_write_b64 v15, v[28:29] offset:64
    s_mov_b64 exec, -1
    s_branch L_STD
L_STW:
    ds_read_b64 v[28:29], v15 offset:64
    s_waitcnt lgkmcnt(0)
    v_cmp_eq_u32 vcc, 0, v29
    s_cbranch_vccz L_STD
    s_cmp_eq_u32 s72, 0
    s_cbranch_scc1 L_STD
    s_sub_u32 s72, s72, 1
    s_sleep 1
    s_branch L_STW
L_STD:
    v_sub_f32 v10, v10, v28
    v_mul_f32 v10, 0x3fb8aa3b, v10
    v_exp_f32 v10, v10
    s_nop 0
    v_mul_f32 v10, v10, v29
    v_mul_f32 v80, v80, v10
    v_mul_f32 v81, v81, v10
    v_mul_f32 v82, v82, v10
    v_mul_f32 v83, v83, v10
    v_cvt_pk_bf16_f32 v8, v80, v81
    v_cvt_pk_bf16_f32 v9, v82, v83
    v_min_u32 v8, -2, v8
    v_min_u32 v9, -2, v9
    s_cmp_eq_u32 s7, 1
    s_cbranch_scc1 PUBL_87
    buffer_store_dwordx2 v[8:9], v4, s[92:95], s81 offen sc1
    s_branch PUBD_88
PUBL_87:
    buffer_store_dwordx2 v[8:9], v4, s[92:95], s81 offen
PUBD_88:
    s_barrier
    s_cmp_eq_u32 s6, 3
    s_cbranch_scc1 L_KW3
    v_lshrrev_b32 v14, 3, v1
    s_mov_b32 s77, 1024
    v_mul_lo_u32 v12, v14, s77
    v_bfe_u32 v14, v1, 4, 1
    v_lshlrev_b32 v14, 1, v14
    v_and_b32 v13, 7, v1
    v_xor_b32 v14, v14, v13
    v_lshlrev_b32 v14, 4, v14
    v_add_u32 v12, v12, v14
    v_xor_b32 v13, 64, v12
    v_and_b32 v16, 0x7f, v12
    v_bfe_u32 v14, v1, 3, 2
    v_lshl_add_u32 v16, v14, 17, v16
    v_lshrrev_b32 v14, 5, v1
    v_lshl_add_u32 v16, v14, 13, v16
    v_xor_b32 v17, 64, v16
    s_lshl_b32 s82, s4, 19
    s_lshl_b32 s83, s74, 10
    s_add_u32 s82, s82, s83
    s_lshr_b32 s83, s3, 3
    s_lshl_b32 s83, s83, 16
    s_add_u32 s82, s82, s83
    s_lshl_b32 s84, s5, 7
    s_add_u32 s82, s82, s84
    s_lshl_b32 s83, s3, 12
    s_add_u32 s78, s82, 0
    s_add_u32 m0, s83, 0
    s_nop 0
    buffer_load_dwordx4 v16, s[20:23], s78 offen nt lds
    s_add_u32 s78, s82, 16384
    s_add_u32 m0, s83, 1024
    s_nop 0
    buffer_load_dwordx4 v17, s[20:23], s78 offen nt lds
    s_add_u32 s78, s82, 32768
    s_add_u32 m0, s83, 2048
    s_nop 0
    buffer_load_dwordx4 v16, s[20:23], s78 offen nt lds
    s_add_u32 s78, s82, 49152
    s_add_u32 m0, s83, 3072
    s_nop 0
    buffer_load_dwordx4 v17, s[20:23], s78 offen nt lds
    s_waitcnt vmcnt(0)
    s_barrier
    s_and_b32 s82, s2, 63
    s_and_b32 s84, s3, 3
    s_cmp_ge_u32 s3, 12
    s_cbranch_scc1 L_WO
    s_cmp_ge_u32 s3, 8
    s_cbranch_scc1 L_DN
    v_lshlrev_b32 v4, 4, v1
    s_lshl_b32 s80, s4, 13
    s_lshl_b32 s81, s3, 10
    s_add_u32 s80, s80, s81
    s_add_u32 s85, s80, 1245184
    s_add_u32 s80, s80, 1048576
    s_mul_i32 s81, s3, 1056
    s_add_u32 s81, s81, 131072
    v_add_u32 v5, s81, v4
    v_bfe_u32 v7, v1, 1, 3
    v_mul_u32_u24 v6, 544, v7
    v_lshrrev_b32 v7, 4, v1
    v_lshl_add_u32 v6, v7, 5, v6
    v_and_b32 v7, 1, v1
    v_lshl_add_u32 v6, v7, 4, v6
    s_lshl_b32 s82, s3, 7
    s_add_u32 s82, s82, 98304
    v_add_u32 v6, s82, v6
    s_add_u32 s86, s85, 4096
POLL_89:
    buffer_load_dwordx4 v[16:19], v4, s[92:95], s80 offen sc1
    s_waitcnt vmcnt(0)
    v_max3_u32 v12, v16, v17, v18
    v_max_u32 v12, v12, v19
    v_cmp_eq_u32 vcc, -1, v12
    s_cbranch_vccz PLD_90
    s_cmp_eq_u32 s72, 0
    s_cbranch_scc1 PLD_90
    s_sub_u32 s72, s72, 1
    s_branch POLL_89
PLD_90:
    ds_write_b128 v5, v[16:19]
    s_waitcnt lgkmcnt(0)
    s_barrier
    s_cmp_ge_u32 s3, 4
    s_cbranch_scc1 L_END
    s_cmp_eq_u32 s4, 7
    s_cbranch_scc1 L_END
POLL_91:
    buffer_load_dwordx4 v[16:19], v4, s[92:95], s85 offen sc1
    buffer_load_dwordx4 v[20:23], v4, s[92:95], s86 offen sc1
    s_waitcnt vmcnt(0)
    v_max3_u32 v12, v16, v17, v18
    v_max3_u32 v12, v12, v19, v20
    v_max3_u32 v12, v12, v21, v22
    v_max_u32 v12, v12, v23
    v_cmp_eq_u32 vcc, -1, v12
    s_cbranch_vccz PLD_92
    s_cmp_eq_u32 s72, 0
    s_cbranch_scc1 PLD_92
    s_sub_u32 s72, s72, 1
    s_branch POLL_91
PLD_92:
    v_lshlrev_b32 v32, 16, v16
    v_and_b32 v33, 0xffff0000, v16
    v_lshlrev_b32 v34, 16, v17
    v_and_b32 v35, 0xffff0000, v17
    v_lshlrev_b32 v36, 16, v18
    v_and_b32 v37, 0xffff0000, v18
    v_lshlrev_b32 v38, 16, v19
    v_and_b32 v39, 0xffff0000, v19
    v_lshlrev_b32 v40, 16, v20
    v_and_b32 v41, 0xffff0000, v20
    v_lshlrev_b32 v42, 16, v21
    v_and_b32 v43, 0xffff0000, v21
    v_lshlrev_b32 v44, 16, v22
    v_and_b32 v45, 0xffff0000, v22
    v_lshlrev_b32 v46, 16, v23
    v_and_b32 v47, 0xffff0000, v23
    v_mul_f32 v32, v32, v40
    v_mul_f32 v33, v33, v41
    v_mul_f32 v34, v34, v42
    v_mul_f32 v35, v35, v43
    v_mul_f32 v36, v36, v44
    v_mul_f32 v37, v37, v45
    v_mul_f32 v38, v38, v46
    v_mul_f32 v39, v39, v47
    v_cvt_pk_bf16_f32 v16, v32, v33
    v_cvt_pk_bf16_f32 v17, v34, v35
    v_cvt_pk_bf16_f32 v18, v36, v37
    v_cvt_pk_bf16_f32 v19, v38, v39
    ds_write_b128 v6, v[16:19]
    s_waitcnt lgkmcnt(0)
    s_barrier
    s_branch L_END
L_WO:
    v_lshrrev_b32 v6, 4, v1
    v_lshlrev_b32 v5, 10, v6
    v_and_b32 v6, 1, v6
    v_lshlrev_b32 v6, 1, v6
    v_bfe_u32 v7, v1, 3, 1
    v_or_b32 v6, v6, v7
    v_xor_b32 v6, s84, v6
    v_lshl_add_u32 v5, v6, 5, v5
    v_bfe_u32 v6, v1, 2, 2
    v_lshl_add_u32 v5, v6, 7, v5
    v_and_b32 v6, 3, v1
    v_lshl_add_u32 v5, v6, 3, v5
    v_add_u32 v5, 0, v5
    ds_read_b64_tr_b16 v[16:17], v5 offset:0
    ds_read_b64_tr_b16 v[18:19], v5 offset:512
    ds_read_b64_tr_b16 v[20:21], v5 offset:4096
    ds_read_b64_tr_b16 v[22:23], v5 offset:4608
    ds_read_b64_tr_b16 v[24:25], v5 offset:8192
    ds_read_b64_tr_b16 v[26:27], v5 offset:8704
    ds_read_b64_tr_b16 v[28:29], v5 offset:12288
    ds_read_b64_tr_b16 v[30:31], v5 offset:12800
    ds_read_b64_tr_b16 v[32:33], v5 offset:16384
    ds_read_b64_tr_b16 v[34:35], v5 offset:16896
    ds_read_b64_tr_b16 v[36:37], v5 offset:20480
    ds_read_b64_tr_b16 v[38:39], v5 offset:20992
    ds_read_b64_tr_b16 v[40:41], v5 offset:24576
    ds_read_b64_tr_b16 v[42:43], v5 offset:25088
    ds_read_b64_tr_b16 v[44:45], v5 offset:28672
    ds_read_b64_tr_b16 v[46:47], v5 offset:29184
    ds_read_b64_tr_b16 v[48:49], v5 offset:32768
    ds_read_b64_tr_b16 v[50:51], v5 offset:33280
    ds_read_b64_tr_b16 v[52:53], v5 offset:36864
    ds_read_b64_tr_b16 v[54:55], v5 offset:37376
    ds_read_b64_tr_b16 v[56:57], v5 offset:40960
    ds_read_b64_tr_b16 v[58:59], v5 offset:41472
    ds_read_b64_tr_b16 v[60:61], v5 offset:45056
    ds_read_b64_tr_b16 v[62:63], v5 offset:45568
    ds_read_b64_tr_b16 v[64:65], v5 offset:49152
    ds_read_b64_tr_b16 v[66:67], v5 offset:49664
    ds_read_b64_tr_b16 v[68:69], v5 offset:53248
    ds_read_b64_tr_b16 v[70:71], v5 offset:53760
    ds_read_b64_tr_b16 v[72:73], v5 offset:57344
    ds_read_b64_tr_b16 v[74:75], v5 offset:57856
    ds_read_b64_tr_b16 v[76:77], v5 offset:61440
    ds_read_b64_tr_b16 v[78:79], v5 offset:61952
    v_and_b32 v7, 7, v1
    v_mul_u32_u24 v6, 1056, v7
    v_lshrrev_b32 v7, 4, v1
    v_lshl_add_u32 v6, v7, 4, v6
    v_add_u32 v6, 131072, v6
    s_lshl_b32 s83, s82, 11
    s_lshl_b32 s85, s84, 9
    s_add_u32 s83, s83, s85
    s_add_u32 s83, s83, 4456448
    v_and_b32 v7, 15, v1
    v_lshlrev_b32 v4, 6, v7
    v_lshrrev_b32 v7, 4, v1
    v_lshl_add_u32 v4, v7, 4, v4
    v_add_u32 v4, s83, v4
    s_waitcnt vmcnt(0) lgkmcnt(0)
    s_barrier
    ds_read_b128 v[80:83], v6 offset:0
    ds_read_b128 v[84:87], v6 offset:64
    ds_read_b128 v[88:91], v6 offset:128
    ds_read_b128 v[92:95], v6 offset:192
    ds_read_b128 v[96:99], v6 offset:256
    ds_read_b128 v[100:103], v6 offset:320
    ds_read_b128 v[104:107], v6 offset:384
    ds_read_b128 v[108:111], v6 offset:448
    s_waitcnt lgkmcnt(7)
    v_mfma_f32_16x16x32_bf16 v[8:11], v[16:19], v[80:83], 0
    s_waitcnt lgkmcnt(6)
    v_mfma_f32_16x16x32_bf16 v[8:11], v[20:23], v[84:87], v[8:11]
    s_waitcnt lgkmcnt(5)
    v_mfma_f32_16x16x32_bf16 v[8:11], v[24:27], v[88:91], v[8:11]
    s_waitcnt lgkmcnt(4)
    v_mfma_f32_16x16x32_bf16 v[8:11], v[28:31], v[92:95], v[8:11]
    ds_read_b128 v[80:83], v6 offset:512
    ds_read_b128 v[84:87], v6 offset:576
    ds_read_b128 v[88:91], v6 offset:640
    ds_read_b128 v[92:95], v6 offset:704
    s_waitcnt lgkmcnt(7)
    v_mfma_f32_16x16x32_bf16 v[8:11], v[32:35], v[96:99], v[8:11]
    s_waitcnt lgkmcnt(6)
    v_mfma_f32_16x16x32_bf16 v[8:11], v[36:39], v[100:103], v[8:11]
    s_waitcnt lgkmcnt(5)
    v_mfma_f32_16x16x32_bf16 v[8:11], v[40:43], v[104:107], v[8:11]
    s_waitcnt lgkmcnt(4)
    v_mfma_f32_16x16x32_bf16 v[8:11], v[44:47], v[108:111], v[8:11]
    ds_read_b128 v[96:99], v6 offset:768
    ds_read_b128 v[100:103], v6 offset:832
    ds_read_b128 v[104:107], v6 offset:896
    ds_read_b128 v[108:111], v6 offset:960
    s_waitcnt lgkmcnt(7)
    v_mfma_f32_16x16x32_bf16 v[8:11], v[48:51], v[80:83], v[8:11]
    s_waitcnt lgkmcnt(6)
    v_mfma_f32_16x16x32_bf16 v[8:11], v[52:55], v[84:87], v[8:11]
    s_waitcnt lgkmcnt(5)
    v_mfma_f32_16x16x32_bf16 v[8:11], v[56:59], v[88:91], v[8:11]
    s_waitcnt lgkmcnt(4)
    v_mfma_f32_16x16x32_bf16 v[8:11], v[60:63], v[92:95], v[8:11]
    s_waitcnt lgkmcnt(3)
    v_mfma_f32_16x16x32_bf16 v[8:11], v[64:67], v[96:99], v[8:11]
    s_waitcnt lgkmcnt(2)
    v_mfma_f32_16x16x32_bf16 v[8:11], v[68:71], v[100:103], v[8:11]
    s_waitcnt lgkmcnt(1)
    v_mfma_f32_16x16x32_bf16 v[8:11], v[72:75], v[104:107], v[8:11]
    s_waitcnt lgkmcnt(0)
    v_mfma_f32_16x16x32_bf16 v[8:11], v[76:79], v[108:111], v[8:11]
    s_nop 7
    v_min_u32 v8, -2, v8
    v_min_u32 v9, -2, v9
    v_min_u32 v10, -2, v10
    v_min_u32 v11, -2, v11
    s_mov_b32 exec_lo, 0x00ff00ff
    s_mov_b32 exec_hi, 0x00ff00ff
    buffer_store_dwordx4 v[8:11], v4, s[16:19], 0 offen sc1
    s_mov_b64 exec, -1
    v_mov_b32 v7, 1
    s_mov_b64 exec, 1
    ds_add_u32 v3, v7 offset:28
    s_mov_b64 exec, -1
    s_branch L_END
L_DN:
    v_lshrrev_b32 v6, 4, v1
    v_lshlrev_b32 v5, 10, v6
    v_and_b32 v6, 1, v6
    v_lshlrev_b32 v6, 1, v6
    v_bfe_u32 v7, v1, 3, 1
    v_or_b32 v6, v6, v7
    v_xor_b32 v6, s84, v6
    v_lshl_add_u32 v5, v6, 5, v5
    v_bfe_u32 v6, v1, 2, 2
    v_lshl_add_u32 v5, v6, 7, v5
    v_and_b32 v6, 3, v1
    v_lshl_add_u32 v5, v6, 3, v5
    v_add_u32 v5, 65536, v5
    v_and_b32 v7, 7, v1
    v_mul_u32_u24 v6, 544, v7
    v_lshrrev_b32 v7, 4, v1
    v_lshl_add_u32 v6, v7, 4, v6
    v_add_u32 v6, 98304, v6
    s_lshl_b32 s83, s82, 11
    s_lshl_b32 s85, s84, 9
    s_add_u32 s83, s83, s85
    s_add_u32 s83, s83, 4587520
    v_and_b32 v7, 15, v1
    v_lshlrev_b32 v4, 6, v7
    v_lshrrev_b32 v7, 4, v1
    v_lshl_add_u32 v4, v7, 4, v4
    v_add_u32 v4, s83, v4
    s_waitcnt vmcnt(0)
    s_barrier
    s_cmp_eq_u32 s4, 7
    s_cbranch_scc1 L_END
    s_lshl_b32 s82, s4, 18
    s_lshl_b32 s83, s84, 16
    s_add_u32 s82, s82, s83
    s_lshl_b32 s83, s5, 7
    s_add_u32 s82, s82, s83
    s_lshl_b32 s83, s84, 13
    s_add_u32 s83, s83, 65536
SPIN_93:
    ds_read_b32 v7, v3 offset:28
    s_waitcnt lgkmcnt(0)
    v_readfirstlane_b32 s76, v7
    s_nop 0
    s_cmp_ge_u32 s76, 4
    s_cbranch_scc1 SPD_94
    s_cmp_eq_u32 s72, 0
    s_cbranch_scc1 SPD_94
    s_sub_u32 s72, s72, 1
    s_sleep 1
    s_branch SPIN_93
SPD_94:
    s_add_u32 s78, s82, 0
    s_add_u32 m0, s83, 0
    s_nop 0
    buffer_load_dwordx4 v12, s[12:15], s78 offen nt lds
    s_add_u32 s78, s82, 8192
    s_add_u32 m0, s83, 1024
    s_nop 0
    buffer_load_dwordx4 v13, s[12:15], s78 offen nt lds
    s_add_u32 s78, s82, 16384
    s_add_u32 m0, s83, 2048
    s_nop 0
    buffer_load_dwordx4 v12, s[12:15], s78 offen nt lds
    s_add_u32 s78, s82, 24576
    s_add_u32 m0, s83, 3072
    s_nop 0
    buffer_load_dwordx4 v13, s[12:15], s78 offen nt lds
    s_add_u32 s78, s82, 32768
    s_add_u32 m0, s83, 4096
    s_nop 0
    buffer_load_dwordx4 v12, s[12:15], s78 offen nt lds
    s_add_u32 s78, s82, 40960
    s_add_u32 m0, s83, 5120
    s_nop 0
    buffer_load_dwordx4 v13, s[12:15], s78 offen nt lds
    s_add_u32 s78, s82, 49152
    s_add_u32 m0, s83, 6144
    s_nop 0
    buffer_load_dwordx4 v12, s[12:15], s78 offen nt lds
    s_add_u32 s78, s82, 57344
    s_add_u32 m0, s83, 7168
    s_nop 0
    buffer_load_dwordx4 v13, s[12:15], s78 offen nt lds
    s_waitcnt vmcnt(0)
    v_mov_b32 v7, 1
    s_mov_b64 exec, 1
    ds_add_u32 v3, v7 offset:16
    s_mov_b64 exec, -1
SPIN_95:
    ds_read_b32 v7, v3 offset:16
    s_waitcnt lgkmcnt(0)
    v_readfirstlane_b32 s76, v7
    s_nop 0
    s_cmp_ge_u32 s76, 4
    s_cbranch_scc1 SPD_96
    s_cmp_eq_u32 s72, 0
    s_cbranch_scc1 SPD_96
    s_sub_u32 s72, s72, 1
    s_branch SPIN_95
SPD_96:
    ds_read_b64_tr_b16 v[16:17], v5 offset:0
    ds_read_b64_tr_b16 v[18:19], v5 offset:512
    ds_read_b64_tr_b16 v[20:21], v5 offset:4096
    ds_read_b64_tr_b16 v[22:23], v5 offset:4608
    ds_read_b64_tr_b16 v[24:25], v5 offset:8192
    ds_read_b64_tr_b16 v[26:27], v5 offset:8704
    ds_read_b64_tr_b16 v[28:29], v5 offset:12288
    ds_read_b64_tr_b16 v[30:31], v5 offset:12800
    ds_read_b64_tr_b16 v[32:33], v5 offset:16384
    ds_read_b64_tr_b16 v[34:35], v5 offset:16896
    ds_read_b64_tr_b16 v[36:37], v5 offset:20480
    ds_read_b64_tr_b16 v[38:39], v5 offset:20992
    ds_read_b64_tr_b16 v[40:41], v5 offset:24576
    ds_read_b64_tr_b16 v[42:43], v5 offset:25088
    ds_read_b64_tr_b16 v[44:45], v5 offset:28672
    ds_read_b64_tr_b16 v[46:47], v5 offset:29184
    s_waitcnt lgkmcnt(0)
    s_barrier
    ds_read_b128 v[48:51], v6 offset:0
    ds_read_b128 v[52:55], v6 offset:64
    ds_read_b128 v[56:59], v6 offset:128
    ds_read_b128 v[60:63], v6 offset:192
    ds_read_b128 v[64:67], v6 offset:256
    ds_read_b128 v[68:71], v6 offset:320
    ds_read_b128 v[72:75], v6 offset:384
    ds_read_b128 v[76:79], v6 offset:448
    s_waitcnt lgkmcnt(7)
    v_mfma_f32_16x16x32_bf16 v[8:11], v[16:19], v[48:51], 0
    s_waitcnt lgkmcnt(6)
    v_mfma_f32_16x16x32_bf16 v[8:11], v[20:23], v[52:55], v[8:11]
    s_waitcnt lgkmcnt(5)
    v_mfma_f32_16x16x32_bf16 v[8:11], v[24:27], v[56:59], v[8:11]
    s_waitcnt lgkmcnt(4)
    v_mfma_f32_16x16x32_bf16 v[8:11], v[28:31], v[60:63], v[8:11]
    s_waitcnt lgkmcnt(3)
    v_mfma_f32_16x16x32_bf16 v[8:11], v[32:35], v[64:67], v[8:11]
    s_waitcnt lgkmcnt(2)
    v_mfma_f32_16x16x32_bf16 v[8:11], v[36:39], v[68:71], v[8:11]
    s_waitcnt lgkmcnt(1)
    v_mfma_f32_16x16x32_bf16 v[8:11], v[40:43], v[72:75], v[8:11]
    s_waitcnt lgkmcnt(0)
    v_mfma_f32_16x16x32_bf16 v[8:11], v[44:47], v[76:79], v[8:11]
    s_nop 7
    v_min_u32 v8, -2, v8
    v_min_u32 v9, -2, v9
    v_min_u32 v10, -2, v10
    v_min_u32 v11, -2, v11
    s_mov_b32 exec_lo, 0x00ff00ff
    s_mov_b32 exec_hi, 0x00ff00ff
    buffer_store_dwordx4 v[8:11], v4, s[16:19], 0 offen sc1
    s_mov_b64 exec, -1
    s_branch L_END
L_KW3:
    s_cmp_eq_u32 s4, 7
    s_cbranch_scc1 L_END
    v_lshrrev_b32 v14, 3, v1
    s_mov_b32 s77, 3584
    v_mul_lo_u32 v12, v14, s77
    v_bfe_u32 v14, v1, 4, 1
    v_lshlrev_b32 v14, 1, v14
    v_and_b32 v13, 7, v1
    v_xor_b32 v14, v14, v13
    v_lshlrev_b32 v14, 4, v14
    v_add_u32 v12, v12, v14
    v_xor_b32 v13, 64, v12
    s_mul_i32 s82, s3, 114688
    s_lshl_b32 s83, s4, 2
    s_and_b32 s84, s5, 3
    s_add_u32 s83, s83, s84
    s_lshl_b32 s83, s83, 7
    s_add_u32 s82, s82, s83
    s_lshl_b32 s83, s3, 12
    s_cmp_lg_u32 s3, 0
    s_cbranch_scc1 L_GUW
    s_lshl_b32 s80, s4, 13
    s_add_u32 s80, s80, 1048576
    v_and_b32 v5, 15, v1
    v_lshlrev_b32 v5, 9, v5
L_GUP:
    buffer_load_dword v16, v5, s[92:95], s80 offen sc1
    s_waitcnt vmcnt(0)
    v_cmp_ne_u32 vcc, -1, v16
    s_nop 0
    s_and_b32 s81, vcc_lo, 0xffff
    s_bcnt1_i32_b32 s81, s81
    s_cmp_ge_u32 s81, 1
    s_cbranch_scc1 L_GUW
    s_cmp_eq_u32 s72, 0
    s_cbranch_scc1 L_GUW
    s_sub_u32 s72, s72, 1
    s_sleep 4
    s_branch L_GUP
L_GUW:
    s_barrier
    s_add_u32 s78, s82, 0
    s_add_u32 m0, s83, 0
    s_nop 0
    buffer_load_dwordx4 v12, s[20:23], s78 offen nt lds
    s_add_u32 s78, s82, 28672
    s_add_u32 m0, s83, 1024
    s_nop 0
    buffer_load_dwordx4 v13, s[20:23], s78 offen nt lds
    s_add_u32 s78, s82, 57344
    s_add_u32 m0, s83, 2048
    s_nop 0
    buffer_load_dwordx4 v12, s[20:23], s78 offen nt lds
    s_add_u32 s78, s82, 86016
    s_add_u32 m0, s83, 3072
    s_nop 0
    buffer_load_dwordx4 v13, s[20:23], s78 offen nt lds
    s_waitcnt vmcnt(0)
    s_barrier
    s_cmp_ge_u32 s3, 12
    s_cbranch_scc1 L_GU
    s_cmp_ge_u32 s3, 8
    s_cbranch_scc1 L_END
    v_lshlrev_b32 v4, 4, v1
    s_lshl_b32 s80, s3, 12
    s_add_u32 s80, s80, 4194304
    s_add_u32 s81, s80, 131072
    ds_read_b32 v13, v3 offset:12
    s_waitcnt lgkmcnt(0)
XP_97:
    buffer_load_dwordx4 v[48:51], v4, s[16:19], s80 offen offset:1024 sc1
    buffer_load_dwordx4 v[52:55], v4, s[16:19], s80 offen offset:2048 sc1
    buffer_load_dwordx4 v[56:59], v4, s[16:19], s81 offen offset:1024 sc1
    buffer_load_dwordx4 v[60:63], v4, s[16:19], s81 offen offset:2048 sc1
    s_waitcnt vmcnt(0)
    v_xor_b32 v56, v56, v48
    v_xor_b32 v57, v57, v49
    v_xor_b32 v58, v58, v50
    v_xor_b32 v59, v59, v51
    v_xor_b32 v60, v60, v52
    v_xor_b32 v61, v61, v53
    v_xor_b32 v62, v62, v54
    v_xor_b32 v63, v63, v55
    v_xor_b32 v12, v56, v13
    v_bitop3_b32 v12, v12, v57, v13 bitop3:0xf6
    v_bitop3_b32 v12, v12, v58, v13 bitop3:0xf6
    v_bitop3_b32 v12, v12, v59, v13 bitop3:0xf6
    v_bitop3_b32 v12, v12, v60, v13 bitop3:0xf6
    v_bitop3_b32 v12, v12, v61, v13 bitop3:0xf6
    v_bitop3_b32 v12, v12, v62, v13 bitop3:0xf6
    v_bitop3_b32 v12, v12, v63, v13 bitop3:0xf6
    v_cmp_ne_u32 vcc, 0, v12
    s_cbranch_vccz XPD_98
    s_cmp_eq_u32 s72, 0
    s_cbranch_scc1 XPD_98
    s_sub_u32 s72, s72, 1
    s_sleep 8
    s_branch XP_97
XPD_98:
    v_lshlrev_b32 v32, 16, v48
    v_and_b32 v33, 0xffff0000, v48
    v_lshlrev_b32 v34, 16, v49
    v_and_b32 v35, 0xffff0000, v49
    v_lshlrev_b32 v36, 16, v50
    v_and_b32 v37, 0xffff0000, v50
    v_lshlrev_b32 v38, 16, v51
    v_and_b32 v39, 0xffff0000, v51
    v_lshlrev_b32 v40, 16, v52
    v_and_b32 v41, 0xffff0000, v52
    v_lshlrev_b32 v42, 16, v53
    v_and_b32 v43, 0xffff0000, v53
    v_lshlrev_b32 v44, 16, v54
    v_and_b32 v45, 0xffff0000, v54
    v_lshlrev_b32 v46, 16, v55
    v_and_b32 v47, 0xffff0000, v55
    v_add_f32 v40, 1.0, v40
    v_add_f32 v41, 1.0, v41
    v_add_f32 v42, 1.0, v42
    v_add_f32 v43, 1.0, v43
    v_add_f32 v44, 1.0, v44
    v_add_f32 v45, 1.0, v45
    v_add_f32 v46, 1.0, v46
    v_add_f32 v47, 1.0, v47
    v_cvt_pk_bf16_f32 v13, v40, v41
    v_lshlrev_b32 v40, 16, v13
    v_and_b32 v41, 0xffff0000, v13
    v_cvt_pk_bf16_f32 v13, v42, v43
    v_lshlrev_b32 v42, 16, v13
    v_and_b32 v43, 0xffff0000, v13
    v_cvt_pk_bf16_f32 v13, v44, v45
    v_lshlrev_b32 v44, 16, v13
    v_and_b32 v45, 0xffff0000, v13
    v_cvt_pk_bf16_f32 v13, v46, v47
    v_lshlrev_b32 v46, 16, v13
    v_and_b32 v47, 0xffff0000, v13
    s_mul_i32 s81, s3, 1056
    s_add_u32 s81, s81, 131072
    v_add_u32 v5, s81, v4
    v_lshrrev_b32 v7, 3, v1
    v_lshlrev_b32 v4, 10, v7
    v_and_b32 v7, 7, v1
    v_lshl_add_u32 v4, v7, 4, v4
    s_lshl_b32 s80, s4, 13
    s_lshl_b32 s81, s3, 7
    s_add_u32 s80, s80, s81
    s_add_u32 s80, s80, 1179648
POLL_99:
    buffer_load_dwordx4 v[8:11], v4, s[92:95], s80 offen sc1
    s_waitcnt vmcnt(0)
    v_max3_u32 v12, v8, v9, v10
    v_max_u32 v12, v12, v11
    v_cmp_eq_u32 vcc, -1, v12
    s_cbranch_vccz PLD_100
    s_cmp_eq_u32 s72, 0
    s_cbranch_scc1 PLD_100
    s_sub_u32 s72, s72, 1
    s_branch POLL_99
PLD_100:
    v_lshlrev_b32 v16, 16, v8
    v_and_b32 v17, 0xffff0000, v8
    v_lshlrev_b32 v18, 16, v9
    v_and_b32 v19, 0xffff0000, v9
    v_lshlrev_b32 v20, 16, v10
    v_and_b32 v21, 0xffff0000, v10
    v_lshlrev_b32 v22, 16, v11
    v_and_b32 v23, 0xffff0000, v11
    v_readfirstlane_b32 s77, v16
    s_nop 1
    v_subrev_f32 v48, s77, v16
    v_subrev_f32 v49, s77, v17
    v_subrev_f32 v50, s77, v18
    v_subrev_f32 v51, s77, v19
    v_subrev_f32 v52, s77, v20
    v_subrev_f32 v53, s77, v21
    v_subrev_f32 v54, s77, v22
    v_subrev_f32 v55, s77, v23
    v_add_f32 v56, v48, v49
    v_mul_f32 v57, v48, v48
    v_fmac_f32 v57, v49, v49
    v_add_f32 v56, v56, v50
    v_fmac_f32 v57, v50, v50
    v_add_f32 v56, v56, v51
    v_fmac_f32 v57, v51, v51
    v_add_f32 v56, v56, v52
    v_fmac_f32 v57, v52, v52
    v_add_f32 v56, v56, v53
    v_fmac_f32 v57, v53, v53
    v_add_f32 v56, v56, v54
    v_fmac_f32 v57, v54, v54
    v_add_f32 v56, v56, v55
    v_fmac_f32 v57, v55, v55
    s_nop 0
    v_add_f32_dpp v56, v56, v56 quad_perm:[1,0,3,2] row_mask:0xf bank_mask:0xf
    v_add_f32_dpp v57, v57, v57 quad_perm:[1,0,3,2] row_mask:0xf bank_mask:0xf
    s_nop 0
    v_add_f32_dpp v56, v56, v56 quad_perm:[2,3,0,1] row_mask:0xf bank_mask:0xf
    v_add_f32_dpp v57, v57, v57 quad_perm:[2,3,0,1] row_mask:0xf bank_mask:0xf
    s_nop 0
    v_add_f32_dpp v56, v56, v56 row_half_mirror row_mask:0xf bank_mask:0xf
    v_add_f32_dpp v57, v57, v57 row_half_mirror row_mask:0xf bank_mask:0xf
    s_nop 0
    v_add_f32_dpp v56, v56, v56 row_mirror row_mask:0xf bank_mask:0xf
    v_add_f32_dpp v57, v57, v57 row_mirror row_mask:0xf bank_mask:0xf
    v_mov_b32 v58, v56
    v_mov_b32 v59, v57
    s_nop 0
    v_permlane16_swap_b32 v56, v58
    v_permlane16_swap_b32 v57, v59
    v_add_f32 v56, v56, v58
    v_add_f32 v57, v57, v59
    v_mov_b32 v58, v56
    v_mov_b32 v59, v57
    s_nop 0
    v_permlane32_swap_b32 v56, v58
    v_permlane32_swap_b32 v57, v59
    v_add_f32 v56, v56, v58
    v_add_f32 v57, v57, v59
    v_mul_f32 v56, 0x3b000000, v56
    v_mul_f32 v57, 0x3b000000, v57
    v_fma_f32 v57, -v56, v56, v57
    v_max_f32 v57, 0, v57
    v_add_f32 v56, s77, v56
    v_cvt_pk_bf16_f32 v58, v56, v57
    v_lshlrev_b32 v56, 16, v58
    v_and_b32 v57, 0xffff0000, v58
    v_add_f32 v57, 0x3727c5ac, v57
    v_cvt_pk_bf16_f32 v58, v57, v57
    v_lshlrev_b32 v57, 16, v58
    v_sqrt_f32 v57, v57
    s_nop 0
    v_cvt_pk_bf16_f32 v58, v57, v57
    v_lshlrev_b32 v57, 16, v58
    v_rcp_f32 v57, v57
    v_sub_f32 v16, v16, v56
    v_sub_f32 v17, v17, v56
    v_sub_f32 v18, v18, v56
    v_sub_f32 v19, v19, v56
    v_sub_f32 v20, v20, v56
    v_sub_f32 v21, v21, v56
    v_sub_f32 v22, v22, v56
    v_sub_f32 v23, v23, v56
    v_cvt_pk_bf16_f32 v48, v16, v17
    v_lshlrev_b32 v16, 16, v48
    v_and_b32 v17, 0xffff0000, v48
    v_cvt_pk_bf16_f32 v49, v18, v19
    v_lshlrev_b32 v18, 16, v49
    v_and_b32 v19, 0xffff0000, v49
    v_cvt_pk_bf16_f32 v50, v20, v21
    v_lshlrev_b32 v20, 16, v50
    v_and_b32 v21, 0xffff0000, v50
    v_cvt_pk_bf16_f32 v51, v22, v23
    v_lshlrev_b32 v22, 16, v51
    v_and_b32 v23, 0xffff0000, v51
    v_mul_f32 v16, v16, v57
    v_mul_f32 v17, v17, v57
    v_mul_f32 v18, v18, v57
    v_mul_f32 v19, v19, v57
    v_mul_f32 v20, v20, v57
    v_mul_f32 v21, v21, v57
    v_mul_f32 v22, v22, v57
    v_mul_f32 v23, v23, v57
    v_cvt_pk_bf16_f32 v48, v16, v17
    v_lshlrev_b32 v16, 16, v48
    v_and_b32 v17, 0xffff0000, v48
    v_cvt_pk_bf16_f32 v49, v18, v19
    v_lshlrev_b32 v18, 16, v49
    v_and_b32 v19, 0xffff0000, v49
    v_cvt_pk_bf16_f32 v50, v20, v21
    v_lshlrev_b32 v20, 16, v50
    v_and_b32 v21, 0xffff0000, v50
    v_cvt_pk_bf16_f32 v51, v22, v23
    v_lshlrev_b32 v22, 16, v51
    v_and_b32 v23, 0xffff0000, v51
    v_mul_f32 v16, v16, v40
    v_mul_f32 v17, v17, v41
    v_mul_f32 v18, v18, v42
    v_mul_f32 v19, v19, v43
    v_mul_f32 v20, v20, v44
    v_mul_f32 v21, v21, v45
    v_mul_f32 v22, v22, v46
    v_mul_f32 v23, v23, v47
    v_cvt_pk_bf16_f32 v48, v16, v17
    v_lshlrev_b32 v16, 16, v48
    v_and_b32 v17, 0xffff0000, v48
    v_cvt_pk_bf16_f32 v49, v18, v19
    v_lshlrev_b32 v18, 16, v49
    v_and_b32 v19, 0xffff0000, v49
    v_cvt_pk_bf16_f32 v50, v20, v21
    v_lshlrev_b32 v20, 16, v50
    v_and_b32 v21, 0xffff0000, v50
    v_cvt_pk_bf16_f32 v51, v22, v23
    v_lshlrev_b32 v22, 16, v51
    v_and_b32 v23, 0xffff0000, v51
    v_add_f32 v16, v16, v32
    v_add_f32 v17, v17, v33
    v_add_f32 v18, v18, v34
    v_add_f32 v19, v19, v35
    v_add_f32 v20, v20, v36
    v_add_f32 v21, v21, v37
    v_add_f32 v22, v22, v38
    v_add_f32 v23, v23, v39
    v_cvt_pk_bf16_f32 v8, v16, v17
    v_cvt_pk_bf16_f32 v9, v18, v19
    v_cvt_pk_bf16_f32 v10, v20, v21
    v_cvt_pk_bf16_f32 v11, v22, v23
    ds_write_b128 v5, v[8:11]
    s_waitcnt lgkmcnt(0)
    s_barrier
    s_branch L_END
L_GU:
    s_and_b32 s84, s3, 3
    v_lshrrev_b32 v6, 4, v1
    v_lshlrev_b32 v5, 10, v6
    v_and_b32 v6, 1, v6
    v_lshlrev_b32 v6, 1, v6
    v_bfe_u32 v7, v1, 3, 1
    v_or_b32 v6, v6, v7
    v_xor_b32 v6, s84, v6
    v_lshl_add_u32 v5, v6, 5, v5
    v_bfe_u32 v6, v1, 2, 2
    v_lshl_add_u32 v5, v6, 7, v5
    v_and_b32 v6, 3, v1
    v_lshl_add_u32 v5, v6, 3, v5
    v_add_u32 v5, 0, v5
    ds_read_b64_tr_b16 v[16:17], v5 offset:0
    ds_read_b64_tr_b16 v[18:19], v5 offset:512
    ds_read_b64_tr_b16 v[20:21], v5 offset:4096
    ds_read_b64_tr_b16 v[22:23], v5 offset:4608
    ds_read_b64_tr_b16 v[24:25], v5 offset:8192
    ds_read_b64_tr_b16 v[26:27], v5 offset:8704
    ds_read_b64_tr_b16 v[28:29], v5 offset:12288
    ds_read_b64_tr_b16 v[30:31], v5 offset:12800
    ds_read_b64_tr_b16 v[32:33], v5 offset:16384
    ds_read_b64_tr_b16 v[34:35], v5 offset:16896
    ds_read_b64_tr_b16 v[36:37], v5 offset:20480
    ds_read_b64_tr_b16 v[38:39], v5 offset:20992
    ds_read_b64_tr_b16 v[40:41], v5 offset:24576
    ds_read_b64_tr_b16 v[42:43], v5 offset:25088
    ds_read_b64_tr_b16 v[44:45], v5 offset:28672
    ds_read_b64_tr_b16 v[46:47], v5 offset:29184
    ds_read_b64_tr_b16 v[48:49], v5 offset:32768
    ds_read_b64_tr_b16 v[50:51], v5 offset:33280
    ds_read_b64_tr_b16 v[52:53], v5 offset:36864
    ds_read_b64_tr_b16 v[54:55], v5 offset:37376
    ds_read_b64_tr_b16 v[56:57], v5 offset:40960
    ds_read_b64_tr_b16 v[58:59], v5 offset:41472
    ds_read_b64_tr_b16 v[60:61], v5 offset:45056
    ds_read_b64_tr_b16 v[62:63], v5 offset:45568
    ds_read_b64_tr_b16 v[64:65], v5 offset:49152
    ds_read_b64_tr_b16 v[66:67], v5 offset:49664
    ds_read_b64_tr_b16 v[68:69], v5 offset:53248
    ds_read_b64_tr_b16 v[70:71], v5 offset:53760
    ds_read_b64_tr_b16 v[72:73], v5 offset:57344
    ds_read_b64_tr_b16 v[74:75], v5 offset:57856
    ds_read_b64_tr_b16 v[76:77], v5 offset:61440
    ds_read_b64_tr_b16 v[78:79], v5 offset:61952
    v_and_b32 v7, 7, v1
    v_mul_u32_u24 v6, 1056, v7
    v_lshrrev_b32 v7, 4, v1
    v_lshl_add_u32 v6, v7, 4, v6
    v_add_u32 v6, 131072, v6
    s_lshl_b32 s83, s73, 10
    s_lshl_b32 s85, s84, 8
    s_add_u32 s83, s83, s85
    s_add_u32 s83, s83, 1245184
    v_and_b32 v7, 15, v1
    v_lshlrev_b32 v4, 5, v7
    v_lshrrev_b32 v7, 4, v1
    v_lshl_add_u32 v4, v7, 3, v4
    s_waitcnt lgkmcnt(0)
    s_barrier
    ds_read_b128 v[80:83], v6 offset:0
    ds_read_b128 v[84:87], v6 offset:64
    ds_read_b128 v[88:91], v6 offset:128
    ds_read_b128 v[92:95], v6 offset:192
    ds_read_b128 v[96:99], v6 offset:256
    ds_read_b128 v[100:103], v6 offset:320
    ds_read_b128 v[104:107], v6 offset:384
    ds_read_b128 v[108:111], v6 offset:448
    s_waitcnt lgkmcnt(7)
    v_mfma_f32_16x16x32_bf16 v[8:11], v[16:19], v[80:83], 0
    s_waitcnt lgkmcnt(6)
    v_mfma_f32_16x16x32_bf16 v[8:11], v[20:23], v[84:87], v[8:11]
    s_waitcnt lgkmcnt(5)
    v_mfma_f32_16x16x32_bf16 v[8:11], v[24:27], v[88:91], v[8:11]
    s_waitcnt lgkmcnt(4)
    v_mfma_f32_16x16x32_bf16 v[8:11], v[28:31], v[92:95], v[8:11]
    ds_read_b128 v[80:83], v6 offset:512
    ds_read_b128 v[84:87], v6 offset:576
    ds_read_b128 v[88:91], v6 offset:640
    ds_read_b128 v[92:95], v6 offset:704
    s_waitcnt lgkmcnt(7)
    v_mfma_f32_16x16x32_bf16 v[8:11], v[32:35], v[96:99], v[8:11]
    s_waitcnt lgkmcnt(6)
    v_mfma_f32_16x16x32_bf16 v[8:11], v[36:39], v[100:103], v[8:11]
    s_waitcnt lgkmcnt(5)
    v_mfma_f32_16x16x32_bf16 v[8:11], v[40:43], v[104:107], v[8:11]
    s_waitcnt lgkmcnt(4)
    v_mfma_f32_16x16x32_bf16 v[8:11], v[44:47], v[108:111], v[8:11]
    ds_read_b128 v[96:99], v6 offset:768
    ds_read_b128 v[100:103], v6 offset:832
    ds_read_b128 v[104:107], v6 offset:896
    ds_read_b128 v[108:111], v6 offset:960
    s_waitcnt lgkmcnt(7)
    v_mfma_f32_16x16x32_bf16 v[8:11], v[48:51], v[80:83], v[8:11]
    s_waitcnt lgkmcnt(6)
    v_mfma_f32_16x16x32_bf16 v[8:11], v[52:55], v[84:87], v[8:11]
    s_waitcnt lgkmcnt(5)
    v_mfma_f32_16x16x32_bf16 v[8:11], v[56:59], v[88:91], v[8:11]
    s_waitcnt lgkmcnt(4)
    v_mfma_f32_16x16x32_bf16 v[8:11], v[60:63], v[92:95], v[8:11]
    s_waitcnt lgkmcnt(3)
    v_mfma_f32_16x16x32_bf16 v[8:11], v[64:67], v[96:99], v[8:11]
    s_waitcnt lgkmcnt(2)
    v_mfma_f32_16x16x32_bf16 v[8:11], v[68:71], v[100:103], v[8:11]
    s_waitcnt lgkmcnt(1)
    v_mfma_f32_16x16x32_bf16 v[8:11], v[72:75], v[104:107], v[8:11]
    s_waitcnt lgkmcnt(0)
    v_mfma_f32_16x16x32_bf16 v[8:11], v[76:79], v[108:111], v[8:11]
    s_nop 7
    v_cvt_pk_bf16_f32 v12, v8, v9
    v_lshlrev_b32 v8, 16, v12
    v_and_b32 v9, 0xffff0000, v12
    v_cvt_pk_bf16_f32 v13, v10, v11
    v_lshlrev_b32 v10, 16, v13
    v_and_b32 v11, 0xffff0000, v13
    s_cmp_ge_u32 s5, 4
    s_cbranch_scc1 L_T2U
    s_mov_b32 s77, 0xbfb8aa3b
    v_mul_f32 v16, s77, v8
    v_mul_f32 v17, s77, v9
    v_mul_f32 v18, s77, v10
    v_mul_f32 v19, s77, v11
    v_exp_f32 v16, v16
    v_exp_f32 v17, v17
    v_exp_f32 v18, v18
    v_exp_f32 v19, v19
    v_add_f32 v16, 1.0, v16
    v_add_f32 v17, 1.0, v17
    v_add_f32 v18, 1.0, v18
    v_add_f32 v19, 1.0, v19
    v_rcp_f32 v16, v16
    v_rcp_f32 v17, v17
    v_rcp_f32 v18, v18
    v_rcp_f32 v19, v19
    v_mul_f32 v8, v8, v16
    v_mul_f32 v9, v9, v17
    v_mul_f32 v10, v10, v18
    v_mul_f32 v11, v11, v19
    v_cvt_pk_bf16_f32 v12, v8, v9
    v_cvt_pk_bf16_f32 v13, v10, v11
L_T2U:
    v_min_u32 v12, -2, v12
    v_min_u32 v13, -2, v13
    s_mov_b32 exec_lo, 0x00ff00ff
    s_mov_b32 exec_hi, 0x00ff00ff
    s_cmp_eq_u32 s7, 1
    s_cbranch_scc1 PUBL_101
    buffer_store_dwordx2 v[12:13], v4, s[92:95], s83 offen sc1
    s_branch PUBD_102
PUBL_101:
    buffer_store_dwordx2 v[12:13], v4, s[92:95], s83 offen
PUBD_102:
    s_mov_b64 exec, -1
L_DUMP:
L_END:
    s_endpgm
L_CODE_END:
.section .rodata,"a"
.p2align 6
.amdhsa_kernel adaLN_cond__sliding_block_cached__swiglu_ffn__decode_kernel
  .amdhsa_next_free_vgpr 128
  .amdhsa_next_free_sgpr 102
  .amdhsa_accum_offset 128
  .amdhsa_group_segment_fixed_size 0
  .amdhsa_kernarg_size 112
  .amdhsa_user_sgpr_count 2
  .amdhsa_user_sgpr_kernarg_segment_ptr 1
  .amdhsa_system_sgpr_workgroup_id_x 1
  .amdhsa_float_denorm_mode_32 3
  .amdhsa_float_denorm_mode_16_64 3
.end_amdhsa_kernel
```
